```python
import torch

def _softmax(x, axis=-1):
    return torch.softmax(x, dim=axis)
def _gelu(x):
    return torch.nn.functional.gelu(x, approximate="tanh")
def _silu(x):
    return torch.nn.functional.silu(x)
def _sigmoid(x):
    return torch.sigmoid(x)
def _layernorm(x, axis=-1, eps=1e-5):
    m = x.mean(dim=axis, keepdim=True)
    v = x.var(dim=axis, keepdim=True, unbiased=False)
    return (x - m) / torch.sqrt(v + eps)
def _scatter_add(tgt, idx, src, axis=0):
    return tgt.clone().index_add_(axis, idx, src)
def _segment_sum(src, seg, n):
    out = torch.zeros((n,) + src.shape[1:], dtype=src.dtype)
    return out.index_add_(0, seg, src)
def _pad(x, pw):
    flat = tuple(v for pair in reversed(pw) for v in pair)
    return torch.nn.functional.pad(x, flat)

kernel_name = 'recurrent_scan__ssm_conv_h3__glu_gated_geglu__prompt'

def setup_inputs():

    _w = (lambda a: (lambda t: t.to(torch.bfloat16) if t.is_floating_point() else t)(torch.as_tensor(a)))
    def _A_setup():
        B, S, D = 1, 2048, 512
        ks = 4
        return {
            "q": _w((lambda *s: torch.randn(*s, dtype=torch.bfloat16) * 0.05)(B, S, D)),
            "k": _w((lambda *s: torch.randn(*s, dtype=torch.bfloat16) * 0.8)(B, S, D)),
            "v": _w((lambda *s: torch.randn(*s, dtype=torch.bfloat16) * 0.8)(B, S, D)),
            "shift_k": _w((lambda *s: torch.randn(*s, dtype=torch.bfloat16) * 0.8)(D, ks) * 0.5),
            "ssm_k": _w((lambda *s: torch.randn(*s, dtype=torch.bfloat16) * 1.6)(D, S) * (1.0 / S ** 0.5)),
            "ssm_D": _w((lambda *s: torch.randn(*s, dtype=torch.bfloat16) * 0.8)(D)),
        }
    _A_in = _A_setup()

    def _B_setup():
        B, S, Dm, Df = 1, 2048, 512, 1376
        return {
            "x": _w((lambda *s: torch.randn(*s, dtype=torch.bfloat16) * 0.05)(B, S, Dm)),
            "w_gate": _w((lambda *s: torch.randn(*s, dtype=torch.bfloat16) * 0.2)(Dm, Df) * (Dm ** -0.5)),
            "w_up": _w((lambda *s: torch.randn(*s, dtype=torch.bfloat16) * 0.2)(Dm, Df) * (Dm ** -0.5)),
            "w_down": _w((lambda *s: torch.randn(*s, dtype=torch.bfloat16) * 0.2)(Df, Dm) * (Df ** -0.5)),
        }
    _B_in = _B_setup()

    return {
        "A_q": _A_in["q"],
        "A_k": _A_in["k"],
        "A_v": _A_in["v"],
        "A_shift_k": _A_in["shift_k"],
        "A_ssm_k": _A_in["ssm_k"],
        "A_ssm_D": _A_in["ssm_D"],
        "B_x": _B_in["x"],
        "B_w_gate": _B_in["w_gate"],
        "B_w_up": _B_in["w_up"],
        "B_w_down": _B_in["w_down"],
    }

def reference(A_q, A_k, A_v, A_shift_k, A_ssm_k, A_ssm_D, B_x, B_w_gate, B_w_up, B_w_down):
    def _A_ref(q, k, v, shift_k, ssm_k, ssm_D):
        B, S, D = q.shape
        ks = shift_k.shape[-1]
        k_pad = _pad(k, ((0, 0), (ks - 1, 0), (0, 0)))
        k_shift = torch.zeros_like(k)
        for t in range(ks):
            k_shift = k_shift + k_pad[:, t:t + S, :] * shift_k[:, ks - 1 - t][None, None, :]
        kv = k_shift * v
        L = 2 * S
        kv_pad = _pad(kv, ((0, 0), (0, S), (0, 0)))
        kf_pad = _pad(ssm_k, ((0, 0), (0, S)))
        kv_f = (lambda x, axes=(-2,-1): torch.fft.rfft2(x.float(), dim=axes))(kv_pad[:, None, :, :], axes=(1, 2))
        kf_f = (lambda x, axes=(-2,-1): torch.fft.rfft2(x.float(), dim=axes))(kf_pad[:, None, :], axes=(1, 2))
        kf_f = (lambda x, *d: x.permute(*d))(kf_f, 1, 2, 0)
        y_f = kv_f * kf_f[None, :, :, :]
        y = (lambda x, s, axes=(-2,-1): torch.fft.irfft2(x, s=s, dim=axes).to(torch.bfloat16))(y_f, (1, L), axes=(1, 2))[:, 0, :S, :]
        y = y + kv * ssm_D[None, None, :]
        return q * y

    def _B_ref(x, w_gate, w_up, w_down):
        g = torch.einsum("bsd,df->bsf", x, w_gate)
        u = torch.einsum("bsd,df->bsf", x, w_up)
        h = _gelu(g) * u
        return torch.einsum("bsf,fd->bsd", h, w_down)

    x = A_q
    xn = _layernorm(x, axis=-1)
    s = _A_ref(xn, A_k, A_v, A_shift_k, A_ssm_k, A_ssm_D)
    g = _silu(_B_ref(xn, B_w_gate, B_w_up, B_w_down))
    return x + s * g
```

```asm
; @launch grid=(256,1,1) block=(512,1,1) lds=163840
.amdgcn_target "amdgcn-amd-amdhsa--gfx950"
.text
.globl recurrent_scan__ssm_conv_h3__glu_gated_geglu__prompt_kernel
.p2align 8
.type recurrent_scan__ssm_conv_h3__glu_gated_geglu__prompt_kernel,@function
recurrent_scan__ssm_conv_h3__glu_gated_geglu__prompt_kernel:
  s_cmp_ge_u32 s2, 256
  s_cbranch_scc1 L_END
  s_load_dwordx16 s[48:63], s[0:1], 0
  s_load_dwordx8 s[64:71], s[0:1], 64
  s_load_dwordx2 s[72:73], s[0:1], 96
  s_getpc_b64 s[86:87]
  v_lshlrev_b32 v1, 6, v0
  v_cmp_gt_u32 vcc, L_CODE_END-recurrent_scan__ssm_conv_h3__glu_gated_geglu__prompt_kernel, v1
  s_and_saveexec_b64 s[100:101], vcc
  global_load_dword v2, v1, s[86:87]
  s_mov_b64 exec, s[100:101]
  v_and_b32 v3, 63, v0
  v_lshrrev_b32 v4, 6, v0
  s_and_b32 s86, s2, 7
  v_readfirstlane_b32 s76, v4
  s_lshr_b32 s87, s2, 3
  s_and_b32 s88, s86, 1
  s_lshl_b32 s88, s88, 3
  s_and_b32 s89, s87, 7
  s_add_u32 s77, s88, s89
  s_lshr_b32 s88, s86, 1
  s_lshl_b32 s88, s88, 2
  s_lshr_b32 s89, s87, 3
  s_add_u32 s78, s88, s89
  s_lshl_b32 s88, s86, 2
  s_and_b32 s89, s87, 3
  s_add_u32 s79, s88, s89
  s_lshr_b32 s80, s87, 2
  s_mul_i32 s88, s78, 96
  s_lshl_b32 s89, s78, 6
  s_add_u32 s89, s89, 352
  s_cmp_lt_u32 s78, 11
  s_cselect_b32 s81, s88, s89
  s_cselect_b32 s82, 3, 2
  s_cmp_ge_u32 s76, 4
  s_cbranch_scc1 L_HELPER
  s_setprio 2
  s_and_b32 s83, s76, 1
  s_lshr_b32 s84, s76, 1
  v_and_b32 v8, 31, v3
  v_lshrrev_b32 v9, 5, v3
  v_bfe_u32 v10, v8, 1, 3
  v_xor_b32 v10, v10, v9
  s_lshl_b32 s86, s83, 1
  v_xor_b32 v10, s86, v10
  s_lshl_b32 s86, s83, 6
  v_add_u32 v8, s86, v8
  v_lshlrev_b32 v8, 7, v8
  v_xor_b32 v11, 0, v10
  v_lshl_add_u32 v56, v11, 4, v8
  v_xor_b32 v11, 2, v10
  v_lshl_add_u32 v57, v11, 4, v8
  v_xor_b32 v11, 4, v10
  v_lshl_add_u32 v58, v11, 4, v8
  v_xor_b32 v11, 6, v10
  v_lshl_add_u32 v59, v11, 4, v8
  v_bfe_u32 v8, v3, 4, 1
  v_lshrrev_b32 v9, 5, v3
  v_bfe_u32 v10, v3, 2, 2
  v_bfe_u32 v11, v3, 1, 1
  v_and_b32 v12, 1, v3
  s_lshl_b32 s86, s84, 1
  v_add_u32 v11, s86, v11
  v_lshlrev_b32 v13, 1, v8
  v_xor_b32 v11, v11, v13
  v_lshlrev_b32 v11, 4, v11
  v_lshl_add_u32 v11, v12, 3, v11
  v_lshl_add_u32 v11, v10, 6, v11
  v_mul_u32_u24 v9, 1536, v9
  v_mul_u32_u24 v8, 12288, v8
  v_add3_u32 v11, v11, v9, v8
  v_add_u32 v11, 16384, v11
  s_mul_i32 s87, s83, 3072
  s_cmp_eq_u32 s83, 0
  s_cselect_b32 s86, 0, 512
  s_add_u32 s88, s86, s87
  v_add_u32 v60, s88, v11
  s_sub_u32 s88, s86, s87
  v_add_u32 v63, s88, v11
  s_cmp_eq_u32 s83, 0
  s_cselect_b32 s86, 256, 256
  s_add_u32 s88, s86, s87
  v_add_u32 v61, s88, v11
  s_sub_u32 s88, s86, s87
  v_add_u32 v64, s88, v11
  s_cmp_eq_u32 s83, 0
  s_cselect_b32 s86, 512, 0
  s_add_u32 s88, s86, s87
  v_add_u32 v62, s88, v11
  s_sub_u32 s88, s86, s87
  v_add_u32 v65, s88, v11
  v_add_u32 v66, 81920, v56
  v_add_u32 v67, 81920, v57
  v_add_u32 v68, 81920, v58
  v_add_u32 v69, 81920, v59
  v_add_u32 v70, 81920, v60
  v_add_u32 v71, 81920, v61
  v_add_u32 v72, 81920, v62
  v_add_u32 v73, 81920, v63
  v_add_u32 v74, 81920, v64
  v_add_u32 v75, 81920, v65
  v_lshrrev_b32 v8, 3, v3
  v_lshrrev_b32 v9, 4, v3
  v_and_b32 v10, 7, v3
  s_lshl_b32 s88, s77, 7
  s_lshl_b32 s89, s76, 5
  s_add_u32 s88, s88, s89
  v_add_u32 v11, 0, v9
  v_xor_b32 v11, v11, v10
  v_lshlrev_b32 v11, 4, v11
  v_add_u32 v12, s88, v8
  v_add_u32 v12, 0, v12
  v_lshl_add_u32 v94, v12, 10, v11
  v_add_u32 v11, 4, v9
  v_xor_b32 v11, v11, v10
  v_lshlrev_b32 v11, 4, v11
  v_add_u32 v12, s88, v8
  v_add_u32 v12, 8, v12
  v_lshl_add_u32 v95, v12, 10, v11
  s_and_b32 s87, s76, 1
  s_lshl_b32 s89, s87, 1
  s_lshr_b32 s90, s76, 1
  s_lshl_b32 s90, s90, 5
  s_lshl_b32 s91, s81, 1
  s_movk_i32 s86, 2752
  v_add_u32 v8, 0, v3
  v_lshrrev_b32 v9, 4, v8
  v_mul_u32_u24 v9, 43, v9
  v_lshrrev_b32 v9, 7, v9
  v_mul_u32_u24 v10, 48, v9
  v_sub_u32 v10, v8, v10
  v_lshrrev_b32 v11, 4, v10
  v_bfe_u32 v12, v10, 2, 2
  v_and_b32 v10, 3, v10
  v_xor_b32 v10, s89, v10
  v_lshl_add_u32 v10, v11, 2, v10
  v_lshl_add_u32 v9, v9, 2, v12
  v_add_u32 v9, s90, v9
  v_mul_u32_u24 v9, s86, v9
  v_lshl_add_u32 v10, v10, 4, v9
  v_add_u32 v96, s91, v10
  v_add_u32 v8, 64, v3
  v_lshrrev_b32 v9, 4, v8
  v_mul_u32_u24 v9, 43, v9
  v_lshrrev_b32 v9, 7, v9
  v_mul_u32_u24 v10, 48, v9
  v_sub_u32 v10, v8, v10
  v_lshrrev_b32 v11, 4, v10
  v_bfe_u32 v12, v10, 2, 2
  v_and_b32 v10, 3, v10
  v_xor_b32 v10, s89, v10
  v_lshl_add_u32 v10, v11, 2, v10
  v_lshl_add_u32 v9, v9, 2, v12
  v_add_u32 v9, s90, v9
  v_mul_u32_u24 v9, s86, v9
  v_lshl_add_u32 v10, v10, 4, v9
  v_add_u32 v97, s91, v10
  v_add_u32 v8, 128, v3
  v_lshrrev_b32 v9, 4, v8
  v_mul_u32_u24 v9, 43, v9
  v_lshrrev_b32 v9, 7, v9
  v_mul_u32_u24 v10, 48, v9
  v_sub_u32 v10, v8, v10
  v_lshrrev_b32 v11, 4, v10
  v_bfe_u32 v12, v10, 2, 2
  v_and_b32 v10, 3, v10
  v_xor_b32 v10, s89, v10
  v_lshl_add_u32 v10, v11, 2, v10
  v_lshl_add_u32 v9, v9, 2, v12
  v_add_u32 v9, s90, v9
  v_mul_u32_u24 v9, s86, v9
  v_lshl_add_u32 v10, v10, 4, v9
  v_add_u32 v98, s91, v10
  s_lshl_b32 s44, s76, 12
  s_mul_i32 s45, s87, 12288
  s_lshr_b32 s90, s76, 1
  s_mul_i32 s90, s90, 6144
  s_add_u32 s45, s45, s90
  s_add_u32 s45, s45, 16384
  v_mov_b32 v160, 0
  v_mov_b32 v161, 0
  v_mov_b32 v162, 0
  v_mov_b32 v163, 0
  v_mov_b32 v164, 0
  v_mov_b32 v165, 0
  v_mov_b32 v166, 0
  v_mov_b32 v167, 0
  v_mov_b32 v168, 0
  v_mov_b32 v169, 0
  v_mov_b32 v170, 0
  v_mov_b32 v171, 0
  v_mov_b32 v172, 0
  v_mov_b32 v173, 0
  v_mov_b32 v174, 0
  v_mov_b32 v175, 0
  v_mov_b32 v176, 0
  v_mov_b32 v177, 0
  v_mov_b32 v178, 0
  v_mov_b32 v179, 0
  v_mov_b32 v180, 0
  v_mov_b32 v181, 0
  v_mov_b32 v182, 0
  v_mov_b32 v183, 0
  v_mov_b32 v184, 0
  v_mov_b32 v185, 0
  v_mov_b32 v186, 0
  v_mov_b32 v187, 0
  v_mov_b32 v188, 0
  v_mov_b32 v189, 0
  v_mov_b32 v190, 0
  v_mov_b32 v191, 0
  v_mov_b32 v192, 0
  v_mov_b32 v193, 0
  v_mov_b32 v194, 0
  v_mov_b32 v195, 0
  v_mov_b32 v196, 0
  v_mov_b32 v197, 0
  v_mov_b32 v198, 0
  v_mov_b32 v199, 0
  v_mov_b32 v200, 0
  v_mov_b32 v201, 0
  v_mov_b32 v202, 0
  v_mov_b32 v203, 0
  v_mov_b32 v204, 0
  v_mov_b32 v205, 0
  v_mov_b32 v206, 0
  v_mov_b32 v207, 0
  v_mov_b32 v208, 0
  v_mov_b32 v209, 0
  v_mov_b32 v210, 0
  v_mov_b32 v211, 0
  v_mov_b32 v212, 0
  v_mov_b32 v213, 0
  v_mov_b32 v214, 0
  v_mov_b32 v215, 0
  v_mov_b32 v216, 0
  v_mov_b32 v217, 0
  v_mov_b32 v218, 0
  v_mov_b32 v219, 0
  v_mov_b32 v220, 0
  v_mov_b32 v221, 0
  v_mov_b32 v222, 0
  v_mov_b32 v223, 0
  v_mov_b32 v224, 0
  v_mov_b32 v225, 0
  v_mov_b32 v226, 0
  v_mov_b32 v227, 0
  v_mov_b32 v228, 0
  v_mov_b32 v229, 0
  v_mov_b32 v230, 0
  v_mov_b32 v231, 0
  v_mov_b32 v232, 0
  v_mov_b32 v233, 0
  v_mov_b32 v234, 0
  v_mov_b32 v235, 0
  v_mov_b32 v236, 0
  v_mov_b32 v237, 0
  v_mov_b32 v238, 0
  v_mov_b32 v239, 0
  v_mov_b32 v240, 0
  v_mov_b32 v241, 0
  v_mov_b32 v242, 0
  v_mov_b32 v243, 0
  v_mov_b32 v244, 0
  v_mov_b32 v245, 0
  v_mov_b32 v246, 0
  v_mov_b32 v247, 0
  v_mov_b32 v248, 0
  v_mov_b32 v249, 0
  v_mov_b32 v250, 0
  v_mov_b32 v251, 0
  v_mov_b32 v252, 0
  v_mov_b32 v253, 0
  v_mov_b32 v254, 0
  v_mov_b32 v255, 0
  v_mov_b32 v80, 0
  v_mov_b32 v81, 0
  v_mov_b32 v82, 0
  v_mov_b32 v83, 0
  v_mov_b32 v84, 0
  v_mov_b32 v85, 0
  v_mov_b32 v86, 0
  v_mov_b32 v87, 0
  v_mov_b32 v88, 0
  v_mov_b32 v89, 0
  v_mov_b32 v90, 0
  v_mov_b32 v91, 0
  v_and_b32 v8, 15, v3
  v_bfe_u32 v9, v3, 4, 1
  v_cmp_eq_u32 vcc, v8, v9
  v_mov_b32 v10, 0x3f803f80
  s_nop 0
  v_cndmask_b32 v76, 0, v10, vcc
  v_mov_b32 v77, v76
  v_mov_b32 v78, v76
  v_mov_b32 v79, v76
  s_waitcnt lgkmcnt(0)
  s_mov_b32 s4, s48
  s_mov_b32 s5, s49
  s_mov_b32 s6, 2097152
  s_mov_b32 s7, 0x20000
  s_mov_b32 s20, s66
  s_mov_b32 s21, s67
  s_mov_b32 s22, 1409024
  s_mov_b32 s23, 0x20000
  s_mov_b32 s32, s68
  s_mov_b32 s33, s69
  s_mov_b32 s34, 2097152
  s_mov_b32 s35, 0x20000
  s_mov_b32 s24, s72
  s_mov_b32 s25, s73
  s_mov_b32 s26, 268435456
  s_mov_b32 s27, 0x20000
  s_and_b32 s86, s78, 3
  s_lshl_b32 s86, s86, 5
  s_lshl_b32 s87, s77, 7
  s_add_u32 s86, s86, s87
  v_and_b32 v9, 31, v3
  v_add_u32 v9, s86, v9
  v_lshlrev_b32 v9, 10, v9
  v_lshrrev_b32 v8, 5, v3
  v_lshl_add_u32 v100, v8, 7, v9
  v_cmp_gt_u32 vcc, 32, v3
  v_mov_b32 v10, 2147483392
  s_nop 0
  v_cndmask_b32 v102, v10, v100, vcc
  s_and_b32 s86, s77, 7
  s_lshl_b32 s86, s86, 3
  v_lshrrev_b32 v8, 4, v3
  v_lshlrev_b32 v11, 6, v8
  v_bfe_u32 v9, v3, 1, 3
  v_add3_u32 v11, v11, v9, s86
  s_movk_i32 s87, 2752
  v_mul_lo_u32 v9, v11, s87
  v_and_b32 v10, 1, v3
  v_lshl_add_u32 v9, v10, 7, v9
  s_lshl_b32 s87, s81, 1
  v_add_u32 v101, s87, v9
  v_mov_b32 v10, 2147483392
  v_cmp_gt_u32 vcc, 48, v3
  s_nop 0
  v_cndmask_b32 v103, v10, v101, vcc
  v_cmp_gt_u32 vcc, 16, v3
  s_nop 1
  v_cndmask_b32 v104, v10, v101, vcc
  s_cmp_eq_u32 s76, 1
  s_cselect_b32 s8, s62, s64
  s_cselect_b32 s9, s63, s65
  s_mov_b32 s10, 1409024
  s_mov_b32 s11, 0x20000
  s_cmp_eq_u32 s76, 0
  s_cbranch_scc0 TC_1
  s_movk_i32 s86, 128
  buffer_load_dword v92, v100, s[4:7], s86 offen
  s_movk_i32 s86, 384
  buffer_load_dword v92, v102, s[4:7], s86 offen
  s_branch TC_2
TC_1:
  s_mov_b32 s86, 176128
  s_cmp_eq_u32 s76, 3
  s_cselect_b32 s86, 0x40000000, s86
  buffer_load_dword v92, v103, s[8:11], s86 offen
TC_2:
  s_cmp_eq_u32 s76, 0
  s_cbranch_scc0 TC_3
  s_movk_i32 s86, 512
  buffer_load_dword v92, v102, s[4:7], s86 offen
  s_branch TC_4
TC_3:
  s_mov_b32 s86, 704512
  s_cmp_eq_u32 s76, 3
  s_cselect_b32 s86, 0x40000000, s86
  buffer_load_dword v92, v104, s[8:11], s86 offen
TC_4:
  s_cmp_eq_u32 s76, 0
  s_cbranch_scc0 TC_5
  s_movk_i32 s86, 640
  buffer_load_dword v92, v102, s[4:7], s86 offen
  s_branch TC_6
TC_5:
  s_mov_b32 s86, 880640
  s_cmp_eq_u32 s76, 3
  s_cselect_b32 s86, 0x40000000, s86
  buffer_load_dword v92, v104, s[8:11], s86 offen
TC_6:
  s_barrier
  s_and_b32 s86, s76, 1
  s_cmp_eq_u32 s86, 0
  s_cselect_b32 s16, s62, s64
  s_cselect_b32 s17, s63, s65
  s_mov_b32 s18, 1409024
  s_mov_b32 s19, 0x20000
  s_mov_b32 s46, 128
  s_add_u32 m0, s44, 40960
  s_nop 0
  buffer_load_dwordx4 v94, s[4:7], s46 offen lds
  s_add_u32 m0, m0, 1024
  s_nop 0
  buffer_load_dwordx4 v95, s[4:7], s46 offen lds
  s_add_u32 m0, m0, 1024
  s_mov_b32 s46, 16512
  buffer_load_dwordx4 v94, s[4:7], s46 offen lds
  s_add_u32 m0, m0, 1024
  s_nop 0
  buffer_load_dwordx4 v95, s[4:7], s46 offen lds
  s_mov_b32 s47, 176128
  s_add_u32 m0, s45, 40960
  s_nop 0
  buffer_load_dwordx4 v96, s[16:19], s47 offen lds
  s_add_u32 m0, m0, 1024
  s_nop 0
  buffer_load_dwordx4 v97, s[16:19], s47 offen lds
  s_add_u32 m0, m0, 1024
  s_nop 0
  buffer_load_dwordx4 v98, s[16:19], s47 offen lds
  s_add_u32 m0, m0, 1024
  s_mov_b32 s47, 220160
  buffer_load_dwordx4 v96, s[16:19], s47 offen lds
  s_add_u32 m0, m0, 1024
  s_nop 0
  buffer_load_dwordx4 v97, s[16:19], s47 offen lds
  s_add_u32 m0, m0, 1024
  s_nop 0
  buffer_load_dwordx4 v98, s[16:19], s47 offen lds
  s_barrier
  ds_read_b128 v[16:19], v56 offset:0
  ds_read_b64_tr_b16 v[24:25], v60 offset:0
  ds_read_b64_tr_b16 v[26:27], v60 offset:768
  ds_read_b128 v[20:23], v56 offset:4096
  ds_read_b64_tr_b16 v[28:29], v61 offset:0
  ds_read_b64_tr_b16 v[30:31], v61 offset:768
  ds_read_b64_tr_b16 v[32:33], v62 offset:0
  ds_read_b64_tr_b16 v[34:35], v62 offset:768
  s_waitcnt lgkmcnt(0)
  v_mfma_f32_32x32x16_bf16 v[160:175], v[24:27], v[16:19], v[160:175]
  ds_read_b128 v[36:39], v57 offset:0
  ds_read_b64_tr_b16 v[44:45], v63 offset:3072
  v_mfma_f32_32x32x16_bf16 v[176:191], v[24:27], v[20:23], v[176:191]
  ds_read_b64_tr_b16 v[46:47], v63 offset:3840
  v_mfma_f32_16x16x32_bf16 v[80:83], v[76:79], v[24:27], v[80:83]
  v_mfma_f32_32x32x16_bf16 v[192:207], v[28:31], v[16:19], v[192:207]
  ds_read_b128 v[40:43], v57 offset:4096
  v_mfma_f32_32x32x16_bf16 v[208:223], v[28:31], v[20:23], v[208:223]
  ds_read_b64_tr_b16 v[48:49], v64 offset:3072
  v_mfma_f32_16x16x32_bf16 v[84:87], v[76:79], v[28:31], v[84:87]
  ds_read_b64_tr_b16 v[50:51], v64 offset:3840
  v_mfma_f32_32x32x16_bf16 v[224:239], v[32:35], v[16:19], v[224:239]
  ds_read_b64_tr_b16 v[52:53], v65 offset:3072
  v_mfma_f32_32x32x16_bf16 v[240:255], v[32:35], v[20:23], v[240:255]
  ds_read_b64_tr_b16 v[54:55], v65 offset:3840
  v_mfma_f32_16x16x32_bf16 v[88:91], v[76:79], v[32:35], v[88:91]
  s_waitcnt lgkmcnt(0)
  s_cmp_eq_u32 s76, 0
  s_cbranch_scc0 TC_7
  s_movk_i32 s86, 768
  buffer_load_dword v92, v102, s[4:7], s86 offen
  s_branch TC_8
TC_7:
  s_mov_b32 s86, 1056768
  s_cmp_eq_u32 s76, 3
  s_cselect_b32 s86, 0x40000000, s86
  buffer_load_dword v92, v104, s[8:11], s86 offen
TC_8:
  v_mfma_f32_32x32x16_bf16 v[160:175], v[44:47], v[36:39], v[160:175]
  ds_read_b128 v[16:19], v58 offset:0
  ds_read_b64_tr_b16 v[24:25], v60 offset:6144
  v_mfma_f32_32x32x16_bf16 v[176:191], v[44:47], v[40:43], v[176:191]
  ds_read_b64_tr_b16 v[26:27], v60 offset:6912
  v_mfma_f32_32x32x16_bf16 v[192:207], v[48:51], v[36:39], v[192:207]
  ds_read_b128 v[20:23], v58 offset:4096
  v_mfma_f32_32x32x16_bf16 v[208:223], v[48:51], v[40:43], v[208:223]
  ds_read_b64_tr_b16 v[28:29], v61 offset:6144
  ds_read_b64_tr_b16 v[30:31], v61 offset:6912
  v_mfma_f32_32x32x16_bf16 v[224:239], v[52:55], v[36:39], v[224:239]
  ds_read_b64_tr_b16 v[32:33], v62 offset:6144
  v_mfma_f32_32x32x16_bf16 v[240:255], v[52:55], v[40:43], v[240:255]
  ds_read_b64_tr_b16 v[34:35], v62 offset:6912
  s_waitcnt lgkmcnt(0)
  v_mfma_f32_32x32x16_bf16 v[160:175], v[24:27], v[16:19], v[160:175]
  ds_read_b128 v[36:39], v59 offset:0
  ds_read_b64_tr_b16 v[44:45], v63 offset:9216
  v_mfma_f32_32x32x16_bf16 v[176:191], v[24:27], v[20:23], v[176:191]
  ds_read_b64_tr_b16 v[46:47], v63 offset:9984
  v_mfma_f32_16x16x32_bf16 v[80:83], v[76:79], v[24:27], v[80:83]
  v_mfma_f32_32x32x16_bf16 v[192:207], v[28:31], v[16:19], v[192:207]
  ds_read_b128 v[40:43], v59 offset:4096
  v_mfma_f32_32x32x16_bf16 v[208:223], v[28:31], v[20:23], v[208:223]
  ds_read_b64_tr_b16 v[48:49], v64 offset:9216
  v_mfma_f32_16x16x32_bf16 v[84:87], v[76:79], v[28:31], v[84:87]
  ds_read_b64_tr_b16 v[50:51], v64 offset:9984
  v_mfma_f32_32x32x16_bf16 v[224:239], v[32:35], v[16:19], v[224:239]
  ds_read_b64_tr_b16 v[52:53], v65 offset:9216
  v_mfma_f32_32x32x16_bf16 v[240:255], v[32:35], v[20:23], v[240:255]
  ds_read_b64_tr_b16 v[54:55], v65 offset:9984
  v_mfma_f32_16x16x32_bf16 v[88:91], v[76:79], v[32:35], v[88:91]
  s_waitcnt vmcnt(1) lgkmcnt(0)
  s_barrier
  v_mfma_f32_32x32x16_bf16 v[160:175], v[44:47], v[36:39], v[160:175]
  ds_read_b128 v[16:19], v56 offset:40960
  ds_read_b64_tr_b16 v[24:25], v60 offset:40960
  v_mfma_f32_32x32x16_bf16 v[176:191], v[44:47], v[40:43], v[176:191]
  ds_read_b64_tr_b16 v[26:27], v60 offset:41728
  v_mfma_f32_32x32x16_bf16 v[192:207], v[48:51], v[36:39], v[192:207]
  ds_read_b128 v[20:23], v56 offset:45056
  v_mfma_f32_32x32x16_bf16 v[208:223], v[48:51], v[40:43], v[208:223]
  ds_read_b64_tr_b16 v[28:29], v61 offset:40960
  ds_read_b64_tr_b16 v[30:31], v61 offset:41728
  v_mfma_f32_32x32x16_bf16 v[224:239], v[52:55], v[36:39], v[224:239]
  ds_read_b64_tr_b16 v[32:33], v62 offset:40960
  v_mfma_f32_32x32x16_bf16 v[240:255], v[52:55], v[40:43], v[240:255]
  ds_read_b64_tr_b16 v[34:35], v62 offset:41728
  s_waitcnt lgkmcnt(0)
  v_mfma_f32_32x32x16_bf16 v[160:175], v[24:27], v[16:19], v[160:175]
  ds_read_b128 v[36:39], v57 offset:40960
  ds_read_b64_tr_b16 v[44:45], v63 offset:44032
  v_mfma_f32_32x32x16_bf16 v[176:191], v[24:27], v[20:23], v[176:191]
  ds_read_b64_tr_b16 v[46:47], v63 offset:44800
  v_mfma_f32_16x16x32_bf16 v[80:83], v[76:79], v[24:27], v[80:83]
  v_mfma_f32_32x32x16_bf16 v[192:207], v[28:31], v[16:19], v[192:207]
  ds_read_b128 v[40:43], v57 offset:45056
  v_mfma_f32_32x32x16_bf16 v[208:223], v[28:31], v[20:23], v[208:223]
  ds_read_b64_tr_b16 v[48:49], v64 offset:44032
  v_mfma_f32_16x16x32_bf16 v[84:87], v[76:79], v[28:31], v[84:87]
  ds_read_b64_tr_b16 v[50:51], v64 offset:44800
  v_mfma_f32_32x32x16_bf16 v[224:239], v[32:35], v[16:19], v[224:239]
  ds_read_b64_tr_b16 v[52:53], v65 offset:44032
  v_mfma_f32_32x32x16_bf16 v[240:255], v[32:35], v[20:23], v[240:255]
  ds_read_b64_tr_b16 v[54:55], v65 offset:44800
  v_mfma_f32_16x16x32_bf16 v[88:91], v[76:79], v[32:35], v[88:91]
  s_waitcnt lgkmcnt(0)
  s_cmp_eq_u32 s76, 0
  s_cbranch_scc0 TC_9
  s_movk_i32 s86, 896
  buffer_load_dword v92, v102, s[4:7], s86 offen
  s_branch TC_10
TC_9:
  s_mov_b32 s86, 1232896
  s_cmp_eq_u32 s76, 3
  s_cselect_b32 s86, 0x40000000, s86
  buffer_load_dword v92, v104, s[8:11], s86 offen
TC_10:
  v_mfma_f32_32x32x16_bf16 v[160:175], v[44:47], v[36:39], v[160:175]
  ds_read_b128 v[16:19], v58 offset:40960
  ds_read_b64_tr_b16 v[24:25], v60 offset:47104
  v_mfma_f32_32x32x16_bf16 v[176:191], v[44:47], v[40:43], v[176:191]
  ds_read_b64_tr_b16 v[26:27], v60 offset:47872
  v_mfma_f32_32x32x16_bf16 v[192:207], v[48:51], v[36:39], v[192:207]
  ds_read_b128 v[20:23], v58 offset:45056
  v_mfma_f32_32x32x16_bf16 v[208:223], v[48:51], v[40:43], v[208:223]
  ds_read_b64_tr_b16 v[28:29], v61 offset:47104
  ds_read_b64_tr_b16 v[30:31], v61 offset:47872
  v_mfma_f32_32x32x16_bf16 v[224:239], v[52:55], v[36:39], v[224:239]
  ds_read_b64_tr_b16 v[32:33], v62 offset:47104
  v_mfma_f32_32x32x16_bf16 v[240:255], v[52:55], v[40:43], v[240:255]
  ds_read_b64_tr_b16 v[34:35], v62 offset:47872
  s_waitcnt lgkmcnt(0)
  v_mfma_f32_32x32x16_bf16 v[160:175], v[24:27], v[16:19], v[160:175]
  ds_read_b128 v[36:39], v59 offset:40960
  ds_read_b64_tr_b16 v[44:45], v63 offset:50176
  v_mfma_f32_32x32x16_bf16 v[176:191], v[24:27], v[20:23], v[176:191]
  ds_read_b64_tr_b16 v[46:47], v63 offset:50944
  v_mfma_f32_16x16x32_bf16 v[80:83], v[76:79], v[24:27], v[80:83]
  v_mfma_f32_32x32x16_bf16 v[192:207], v[28:31], v[16:19], v[192:207]
  ds_read_b128 v[40:43], v59 offset:45056
  v_mfma_f32_32x32x16_bf16 v[208:223], v[28:31], v[20:23], v[208:223]
  ds_read_b64_tr_b16 v[48:49], v64 offset:50176
  v_mfma_f32_16x16x32_bf16 v[84:87], v[76:79], v[28:31], v[84:87]
  ds_read_b64_tr_b16 v[50:51], v64 offset:50944
  v_mfma_f32_32x32x16_bf16 v[224:239], v[32:35], v[16:19], v[224:239]
  ds_read_b64_tr_b16 v[52:53], v65 offset:50176
  v_mfma_f32_32x32x16_bf16 v[240:255], v[32:35], v[20:23], v[240:255]
  ds_read_b64_tr_b16 v[54:55], v65 offset:50944
  v_mfma_f32_16x16x32_bf16 v[88:91], v[76:79], v[32:35], v[88:91]
  s_waitcnt lgkmcnt(0)
  s_barrier
  v_mfma_f32_32x32x16_bf16 v[160:175], v[44:47], v[36:39], v[160:175]
  ds_read_b128 v[16:19], v66 offset:0
  ds_read_b64_tr_b16 v[24:25], v70 offset:0
  v_mfma_f32_32x32x16_bf16 v[176:191], v[44:47], v[40:43], v[176:191]
  ds_read_b64_tr_b16 v[26:27], v70 offset:768
  v_mfma_f32_32x32x16_bf16 v[192:207], v[48:51], v[36:39], v[192:207]
  ds_read_b128 v[20:23], v66 offset:4096
  v_mfma_f32_32x32x16_bf16 v[208:223], v[48:51], v[40:43], v[208:223]
  ds_read_b64_tr_b16 v[28:29], v71 offset:0
  ds_read_b64_tr_b16 v[30:31], v71 offset:768
  v_mfma_f32_32x32x16_bf16 v[224:239], v[52:55], v[36:39], v[224:239]
  ds_read_b64_tr_b16 v[32:33], v72 offset:0
  v_mfma_f32_32x32x16_bf16 v[240:255], v[52:55], v[40:43], v[240:255]
  ds_read_b64_tr_b16 v[34:35], v72 offset:768
  s_waitcnt lgkmcnt(0)
  v_mfma_f32_32x32x16_bf16 v[160:175], v[24:27], v[16:19], v[160:175]
  ds_read_b128 v[36:39], v67 offset:0
  ds_read_b64_tr_b16 v[44:45], v73 offset:3072
  v_mfma_f32_32x32x16_bf16 v[176:191], v[24:27], v[20:23], v[176:191]
  ds_read_b64_tr_b16 v[46:47], v73 offset:3840
  v_mfma_f32_16x16x32_bf16 v[80:83], v[76:79], v[24:27], v[80:83]
  v_mfma_f32_32x32x16_bf16 v[192:207], v[28:31], v[16:19], v[192:207]
  ds_read_b128 v[40:43], v67 offset:4096
  v_mfma_f32_32x32x16_bf16 v[208:223], v[28:31], v[20:23], v[208:223]
  ds_read_b64_tr_b16 v[48:49], v74 offset:3072
  v_mfma_f32_16x16x32_bf16 v[84:87], v[76:79], v[28:31], v[84:87]
  ds_read_b64_tr_b16 v[50:51], v74 offset:3840
  v_mfma_f32_32x32x16_bf16 v[224:239], v[32:35], v[16:19], v[224:239]
  ds_read_b64_tr_b16 v[52:53], v75 offset:3072
  v_mfma_f32_32x32x16_bf16 v[240:255], v[32:35], v[20:23], v[240:255]
  ds_read_b64_tr_b16 v[54:55], v75 offset:3840
  v_mfma_f32_16x16x32_bf16 v[88:91], v[76:79], v[32:35], v[88:91]
  s_waitcnt lgkmcnt(0)
  v_mfma_f32_32x32x16_bf16 v[160:175], v[44:47], v[36:39], v[160:175]
  ds_read_b128 v[16:19], v68 offset:0
  ds_read_b64_tr_b16 v[24:25], v70 offset:6144
  v_mfma_f32_32x32x16_bf16 v[176:191], v[44:47], v[40:43], v[176:191]
  ds_read_b64_tr_b16 v[26:27], v70 offset:6912
  v_mfma_f32_32x32x16_bf16 v[192:207], v[48:51], v[36:39], v[192:207]
  ds_read_b128 v[20:23], v68 offset:4096
  v_mfma_f32_32x32x16_bf16 v[208:223], v[48:51], v[40:43], v[208:223]
  ds_read_b64_tr_b16 v[28:29], v71 offset:6144
  ds_read_b64_tr_b16 v[30:31], v71 offset:6912
  v_mfma_f32_32x32x16_bf16 v[224:239], v[52:55], v[36:39], v[224:239]
  ds_read_b64_tr_b16 v[32:33], v72 offset:6144
  v_mfma_f32_32x32x16_bf16 v[240:255], v[52:55], v[40:43], v[240:255]
  ds_read_b64_tr_b16 v[34:35], v72 offset:6912
  s_waitcnt lgkmcnt(0)
  v_mfma_f32_32x32x16_bf16 v[160:175], v[24:27], v[16:19], v[160:175]
  ds_read_b128 v[36:39], v69 offset:0
  ds_read_b64_tr_b16 v[44:45], v73 offset:9216
  v_mfma_f32_32x32x16_bf16 v[176:191], v[24:27], v[20:23], v[176:191]
  ds_read_b64_tr_b16 v[46:47], v73 offset:9984
  v_mfma_f32_16x16x32_bf16 v[80:83], v[76:79], v[24:27], v[80:83]
  v_mfma_f32_32x32x16_bf16 v[192:207], v[28:31], v[16:19], v[192:207]
  ds_read_b128 v[40:43], v69 offset:4096
  v_mfma_f32_32x32x16_bf16 v[208:223], v[28:31], v[20:23], v[208:223]
  ds_read_b64_tr_b16 v[48:49], v74 offset:9216
  v_mfma_f32_16x16x32_bf16 v[84:87], v[76:79], v[28:31], v[84:87]
  ds_read_b64_tr_b16 v[50:51], v74 offset:9984
  v_mfma_f32_32x32x16_bf16 v[224:239], v[32:35], v[16:19], v[224:239]
  ds_read_b64_tr_b16 v[52:53], v75 offset:9216
  v_mfma_f32_32x32x16_bf16 v[240:255], v[32:35], v[20:23], v[240:255]
  ds_read_b64_tr_b16 v[54:55], v75 offset:9984
  v_mfma_f32_16x16x32_bf16 v[88:91], v[76:79], v[32:35], v[88:91]
  s_waitcnt lgkmcnt(0)
  s_barrier
  v_mfma_f32_32x32x16_bf16 v[160:175], v[44:47], v[36:39], v[160:175]
  ds_read_b128 v[16:19], v56 offset:0
  ds_read_b64_tr_b16 v[24:25], v60 offset:0
  v_mfma_f32_32x32x16_bf16 v[176:191], v[44:47], v[40:43], v[176:191]
  ds_read_b64_tr_b16 v[26:27], v60 offset:768
  v_mfma_f32_32x32x16_bf16 v[192:207], v[48:51], v[36:39], v[192:207]
  ds_read_b128 v[20:23], v56 offset:4096
  v_mfma_f32_32x32x16_bf16 v[208:223], v[48:51], v[40:43], v[208:223]
  ds_read_b64_tr_b16 v[28:29], v61 offset:0
  ds_read_b64_tr_b16 v[30:31], v61 offset:768
  v_mfma_f32_32x32x16_bf16 v[224:239], v[52:55], v[36:39], v[224:239]
  ds_read_b64_tr_b16 v[32:33], v62 offset:0
  v_mfma_f32_32x32x16_bf16 v[240:255], v[52:55], v[40:43], v[240:255]
  ds_read_b64_tr_b16 v[34:35], v62 offset:768
  s_waitcnt lgkmcnt(0)
  v_mfma_f32_32x32x16_bf16 v[160:175], v[24:27], v[16:19], v[160:175]
  ds_read_b128 v[36:39], v57 offset:0
  ds_read_b64_tr_b16 v[44:45], v63 offset:3072
  v_mfma_f32_32x32x16_bf16 v[176:191], v[24:27], v[20:23], v[176:191]
  ds_read_b64_tr_b16 v[46:47], v63 offset:3840
  v_mfma_f32_16x16x32_bf16 v[80:83], v[76:79], v[24:27], v[80:83]
  v_mfma_f32_32x32x16_bf16 v[192:207], v[28:31], v[16:19], v[192:207]
  ds_read_b128 v[40:43], v57 offset:4096
  v_mfma_f32_32x32x16_bf16 v[208:223], v[28:31], v[20:23], v[208:223]
  ds_read_b64_tr_b16 v[48:49], v64 offset:3072
  v_mfma_f32_16x16x32_bf16 v[84:87], v[76:79], v[28:31], v[84:87]
  ds_read_b64_tr_b16 v[50:51], v64 offset:3840
  v_mfma_f32_32x32x16_bf16 v[224:239], v[32:35], v[16:19], v[224:239]
  ds_read_b64_tr_b16 v[52:53], v65 offset:3072
  v_mfma_f32_32x32x16_bf16 v[240:255], v[32:35], v[20:23], v[240:255]
  ds_read_b64_tr_b16 v[54:55], v65 offset:3840
  v_mfma_f32_16x16x32_bf16 v[88:91], v[76:79], v[32:35], v[88:91]
  s_waitcnt lgkmcnt(0)
  v_mfma_f32_32x32x16_bf16 v[160:175], v[44:47], v[36:39], v[160:175]
  ds_read_b128 v[16:19], v58 offset:0
  ds_read_b64_tr_b16 v[24:25], v60 offset:6144
  v_mfma_f32_32x32x16_bf16 v[176:191], v[44:47], v[40:43], v[176:191]
  ds_read_b64_tr_b16 v[26:27], v60 offset:6912
  v_mfma_f32_32x32x16_bf16 v[192:207], v[48:51], v[36:39], v[192:207]
  ds_read_b128 v[20:23], v58 offset:4096
  v_mfma_f32_32x32x16_bf16 v[208:223], v[48:51], v[40:43], v[208:223]
  ds_read_b64_tr_b16 v[28:29], v61 offset:6144
  ds_read_b64_tr_b16 v[30:31], v61 offset:6912
  v_mfma_f32_32x32x16_bf16 v[224:239], v[52:55], v[36:39], v[224:239]
  ds_read_b64_tr_b16 v[32:33], v62 offset:6144
  v_mfma_f32_32x32x16_bf16 v[240:255], v[52:55], v[40:43], v[240:255]
  ds_read_b64_tr_b16 v[34:35], v62 offset:6912
  s_waitcnt lgkmcnt(0)
  v_mfma_f32_32x32x16_bf16 v[160:175], v[24:27], v[16:19], v[160:175]
  ds_read_b128 v[36:39], v59 offset:0
  ds_read_b64_tr_b16 v[44:45], v63 offset:9216
  v_mfma_f32_32x32x16_bf16 v[176:191], v[24:27], v[20:23], v[176:191]
  ds_read_b64_tr_b16 v[46:47], v63 offset:9984
  v_mfma_f32_16x16x32_bf16 v[80:83], v[76:79], v[24:27], v[80:83]
  v_mfma_f32_32x32x16_bf16 v[192:207], v[28:31], v[16:19], v[192:207]
  ds_read_b128 v[40:43], v59 offset:4096
  v_mfma_f32_32x32x16_bf16 v[208:223], v[28:31], v[20:23], v[208:223]
  ds_read_b64_tr_b16 v[48:49], v64 offset:9216
  v_mfma_f32_16x16x32_bf16 v[84:87], v[76:79], v[28:31], v[84:87]
  ds_read_b64_tr_b16 v[50:51], v64 offset:9984
  v_mfma_f32_32x32x16_bf16 v[224:239], v[32:35], v[16:19], v[224:239]
  ds_read_b64_tr_b16 v[52:53], v65 offset:9216
  v_mfma_f32_32x32x16_bf16 v[240:255], v[32:35], v[20:23], v[240:255]
  ds_read_b64_tr_b16 v[54:55], v65 offset:9984
  v_mfma_f32_16x16x32_bf16 v[88:91], v[76:79], v[32:35], v[88:91]
  s_waitcnt lgkmcnt(0)
  s_barrier
  v_mfma_f32_32x32x16_bf16 v[160:175], v[44:47], v[36:39], v[160:175]
  ds_read_b128 v[16:19], v56 offset:40960
  ds_read_b64_tr_b16 v[24:25], v60 offset:40960
  v_mfma_f32_32x32x16_bf16 v[176:191], v[44:47], v[40:43], v[176:191]
  ds_read_b64_tr_b16 v[26:27], v60 offset:41728
  v_mfma_f32_32x32x16_bf16 v[192:207], v[48:51], v[36:39], v[192:207]
  ds_read_b128 v[20:23], v56 offset:45056
  v_mfma_f32_32x32x16_bf16 v[208:223], v[48:51], v[40:43], v[208:223]
  ds_read_b64_tr_b16 v[28:29], v61 offset:40960
  ds_read_b64_tr_b16 v[30:31], v61 offset:41728
  v_mfma_f32_32x32x16_bf16 v[224:239], v[52:55], v[36:39], v[224:239]
  ds_read_b64_tr_b16 v[32:33], v62 offset:40960
  v_mfma_f32_32x32x16_bf16 v[240:255], v[52:55], v[40:43], v[240:255]
  ds_read_b64_tr_b16 v[34:35], v62 offset:41728
  s_waitcnt lgkmcnt(0)
  v_mfma_f32_32x32x16_bf16 v[160:175], v[24:27], v[16:19], v[160:175]
  ds_read_b128 v[36:39], v57 offset:40960
  ds_read_b64_tr_b16 v[44:45], v63 offset:44032
  v_mfma_f32_32x32x16_bf16 v[176:191], v[24:27], v[20:23], v[176:191]
  ds_read_b64_tr_b16 v[46:47], v63 offset:44800
  v_mfma_f32_16x16x32_bf16 v[80:83], v[76:79], v[24:27], v[80:83]
  v_mfma_f32_32x32x16_bf16 v[192:207], v[28:31], v[16:19], v[192:207]
  ds_read_b128 v[40:43], v57 offset:45056
  v_mfma_f32_32x32x16_bf16 v[208:223], v[28:31], v[20:23], v[208:223]
  ds_read_b64_tr_b16 v[48:49], v64 offset:44032
  v_mfma_f32_16x16x32_bf16 v[84:87], v[76:79], v[28:31], v[84:87]
  ds_read_b64_tr_b16 v[50:51], v64 offset:44800
  v_mfma_f32_32x32x16_bf16 v[224:239], v[32:35], v[16:19], v[224:239]
  ds_read_b64_tr_b16 v[52:53], v65 offset:44032
  v_mfma_f32_32x32x16_bf16 v[240:255], v[32:35], v[20:23], v[240:255]
  ds_read_b64_tr_b16 v[54:55], v65 offset:44800
  v_mfma_f32_16x16x32_bf16 v[88:91], v[76:79], v[32:35], v[88:91]
  s_waitcnt lgkmcnt(0)
  v_mfma_f32_32x32x16_bf16 v[160:175], v[44:47], v[36:39], v[160:175]
  ds_read_b128 v[16:19], v58 offset:40960
  ds_read_b64_tr_b16 v[24:25], v60 offset:47104
  v_mfma_f32_32x32x16_bf16 v[176:191], v[44:47], v[40:43], v[176:191]
  ds_read_b64_tr_b16 v[26:27], v60 offset:47872
  v_mfma_f32_32x32x16_bf16 v[192:207], v[48:51], v[36:39], v[192:207]
  ds_read_b128 v[20:23], v58 offset:45056
  v_mfma_f32_32x32x16_bf16 v[208:223], v[48:51], v[40:43], v[208:223]
  ds_read_b64_tr_b16 v[28:29], v61 offset:47104
  ds_read_b64_tr_b16 v[30:31], v61 offset:47872
  v_mfma_f32_32x32x16_bf16 v[224:239], v[52:55], v[36:39], v[224:239]
  ds_read_b64_tr_b16 v[32:33], v62 offset:47104
  v_mfma_f32_32x32x16_bf16 v[240:255], v[52:55], v[40:43], v[240:255]
  ds_read_b64_tr_b16 v[34:35], v62 offset:47872
  s_waitcnt lgkmcnt(0)
  v_mfma_f32_32x32x16_bf16 v[160:175], v[24:27], v[16:19], v[160:175]
  ds_read_b128 v[36:39], v59 offset:40960
  ds_read_b64_tr_b16 v[44:45], v63 offset:50176
  v_mfma_f32_32x32x16_bf16 v[176:191], v[24:27], v[20:23], v[176:191]
  ds_read_b64_tr_b16 v[46:47], v63 offset:50944
  v_mfma_f32_16x16x32_bf16 v[80:83], v[76:79], v[24:27], v[80:83]
  v_mfma_f32_32x32x16_bf16 v[192:207], v[28:31], v[16:19], v[192:207]
  ds_read_b128 v[40:43], v59 offset:45056
  v_mfma_f32_32x32x16_bf16 v[208:223], v[28:31], v[20:23], v[208:223]
  ds_read_b64_tr_b16 v[48:49], v64 offset:50176
  v_mfma_f32_16x16x32_bf16 v[84:87], v[76:79], v[28:31], v[84:87]
  ds_read_b64_tr_b16 v[50:51], v64 offset:50944
  v_mfma_f32_32x32x16_bf16 v[224:239], v[32:35], v[16:19], v[224:239]
  ds_read_b64_tr_b16 v[52:53], v65 offset:50176
  v_mfma_f32_32x32x16_bf16 v[240:255], v[32:35], v[20:23], v[240:255]
  ds_read_b64_tr_b16 v[54:55], v65 offset:50944
  v_mfma_f32_16x16x32_bf16 v[88:91], v[76:79], v[32:35], v[88:91]
  s_waitcnt lgkmcnt(0)
  s_barrier
  v_mfma_f32_32x32x16_bf16 v[160:175], v[44:47], v[36:39], v[160:175]
  ds_read_b128 v[16:19], v66 offset:0
  ds_read_b64_tr_b16 v[24:25], v70 offset:0
  v_mfma_f32_32x32x16_bf16 v[176:191], v[44:47], v[40:43], v[176:191]
  ds_read_b64_tr_b16 v[26:27], v70 offset:768
  v_mfma_f32_32x32x16_bf16 v[192:207], v[48:51], v[36:39], v[192:207]
  ds_read_b128 v[20:23], v66 offset:4096
  v_mfma_f32_32x32x16_bf16 v[208:223], v[48:51], v[40:43], v[208:223]
  ds_read_b64_tr_b16 v[28:29], v71 offset:0
  ds_read_b64_tr_b16 v[30:31], v71 offset:768
  v_mfma_f32_32x32x16_bf16 v[224:239], v[52:55], v[36:39], v[224:239]
  ds_read_b64_tr_b16 v[32:33], v72 offset:0
  v_mfma_f32_32x32x16_bf16 v[240:255], v[52:55], v[40:43], v[240:255]
  ds_read_b64_tr_b16 v[34:35], v72 offset:768
  s_waitcnt lgkmcnt(0)
  v_mfma_f32_32x32x16_bf16 v[160:175], v[24:27], v[16:19], v[160:175]
  ds_read_b128 v[36:39], v67 offset:0
  ds_read_b64_tr_b16 v[44:45], v73 offset:3072
  v_mfma_f32_32x32x16_bf16 v[176:191], v[24:27], v[20:23], v[176:191]
  ds_read_b64_tr_b16 v[46:47], v73 offset:3840
  v_mfma_f32_16x16x32_bf16 v[80:83], v[76:79], v[24:27], v[80:83]
  v_mfma_f32_32x32x16_bf16 v[192:207], v[28:31], v[16:19], v[192:207]
  ds_read_b128 v[40:43], v67 offset:4096
  v_mfma_f32_32x32x16_bf16 v[208:223], v[28:31], v[20:23], v[208:223]
  ds_read_b64_tr_b16 v[48:49], v74 offset:3072
  v_mfma_f32_16x16x32_bf16 v[84:87], v[76:79], v[28:31], v[84:87]
  ds_read_b64_tr_b16 v[50:51], v74 offset:3840
  v_mfma_f32_32x32x16_bf16 v[224:239], v[32:35], v[16:19], v[224:239]
  ds_read_b64_tr_b16 v[52:53], v75 offset:3072
  v_mfma_f32_32x32x16_bf16 v[240:255], v[32:35], v[20:23], v[240:255]
  ds_read_b64_tr_b16 v[54:55], v75 offset:3840
  v_mfma_f32_16x16x32_bf16 v[88:91], v[76:79], v[32:35], v[88:91]
  s_waitcnt lgkmcnt(0)
  v_mfma_f32_32x32x16_bf16 v[160:175], v[44:47], v[36:39], v[160:175]
  ds_read_b128 v[16:19], v68 offset:0
  ds_read_b64_tr_b16 v[24:25], v70 offset:6144
  v_mfma_f32_32x32x16_bf16 v[176:191], v[44:47], v[40:43], v[176:191]
  ds_read_b64_tr_b16 v[26:27], v70 offset:6912
  v_mfma_f32_32x32x16_bf16 v[192:207], v[48:51], v[36:39], v[192:207]
  ds_read_b128 v[20:23], v68 offset:4096
  v_mfma_f32_32x32x16_bf16 v[208:223], v[48:51], v[40:43], v[208:223]
  ds_read_b64_tr_b16 v[28:29], v71 offset:6144
  ds_read_b64_tr_b16 v[30:31], v71 offset:6912
  v_mfma_f32_32x32x16_bf16 v[224:239], v[52:55], v[36:39], v[224:239]
  ds_read_b64_tr_b16 v[32:33], v72 offset:6144
  v_mfma_f32_32x32x16_bf16 v[240:255], v[52:55], v[40:43], v[240:255]
  ds_read_b64_tr_b16 v[34:35], v72 offset:6912
  s_waitcnt lgkmcnt(0)
  v_mfma_f32_32x32x16_bf16 v[160:175], v[24:27], v[16:19], v[160:175]
  ds_read_b128 v[36:39], v69 offset:0
  ds_read_b64_tr_b16 v[44:45], v73 offset:9216
  v_mfma_f32_32x32x16_bf16 v[176:191], v[24:27], v[20:23], v[176:191]
  ds_read_b64_tr_b16 v[46:47], v73 offset:9984
  v_mfma_f32_16x16x32_bf16 v[80:83], v[76:79], v[24:27], v[80:83]
  v_mfma_f32_32x32x16_bf16 v[192:207], v[28:31], v[16:19], v[192:207]
  ds_read_b128 v[40:43], v69 offset:4096
  v_mfma_f32_32x32x16_bf16 v[208:223], v[28:31], v[20:23], v[208:223]
  ds_read_b64_tr_b16 v[48:49], v74 offset:9216
  v_mfma_f32_16x16x32_bf16 v[84:87], v[76:79], v[28:31], v[84:87]
  ds_read_b64_tr_b16 v[50:51], v74 offset:9984
  v_mfma_f32_32x32x16_bf16 v[224:239], v[32:35], v[16:19], v[224:239]
  ds_read_b64_tr_b16 v[52:53], v75 offset:9216
  v_mfma_f32_32x32x16_bf16 v[240:255], v[32:35], v[20:23], v[240:255]
  ds_read_b64_tr_b16 v[54:55], v75 offset:9984
  v_mfma_f32_16x16x32_bf16 v[88:91], v[76:79], v[32:35], v[88:91]
  s_waitcnt lgkmcnt(0)
  s_barrier
  v_mfma_f32_32x32x16_bf16 v[160:175], v[44:47], v[36:39], v[160:175]
  ds_read_b128 v[16:19], v56 offset:0
  ds_read_b64_tr_b16 v[24:25], v60 offset:0
  v_mfma_f32_32x32x16_bf16 v[176:191], v[44:47], v[40:43], v[176:191]
  ds_read_b64_tr_b16 v[26:27], v60 offset:768
  v_mfma_f32_32x32x16_bf16 v[192:207], v[48:51], v[36:39], v[192:207]
  ds_read_b128 v[20:23], v56 offset:4096
  v_mfma_f32_32x32x16_bf16 v[208:223], v[48:51], v[40:43], v[208:223]
  ds_read_b64_tr_b16 v[28:29], v61 offset:0
  ds_read_b64_tr_b16 v[30:31], v61 offset:768
  v_mfma_f32_32x32x16_bf16 v[224:239], v[52:55], v[36:39], v[224:239]
  ds_read_b64_tr_b16 v[32:33], v62 offset:0
  v_mfma_f32_32x32x16_bf16 v[240:255], v[52:55], v[40:43], v[240:255]
  ds_read_b64_tr_b16 v[34:35], v62 offset:768
  s_waitcnt lgkmcnt(0)
  v_mfma_f32_32x32x16_bf16 v[160:175], v[24:27], v[16:19], v[160:175]
  ds_read_b128 v[36:39], v57 offset:0
  ds_read_b64_tr_b16 v[44:45], v63 offset:3072
  v_mfma_f32_32x32x16_bf16 v[176:191], v[24:27], v[20:23], v[176:191]
  ds_read_b64_tr_b16 v[46:47], v63 offset:3840
  v_mfma_f32_16x16x32_bf16 v[80:83], v[76:79], v[24:27], v[80:83]
  v_mfma_f32_32x32x16_bf16 v[192:207], v[28:31], v[16:19], v[192:207]
  ds_read_b128 v[40:43], v57 offset:4096
  v_mfma_f32_32x32x16_bf16 v[208:223], v[28:31], v[20:23], v[208:223]
  ds_read_b64_tr_b16 v[48:49], v64 offset:3072
  v_mfma_f32_16x16x32_bf16 v[84:87], v[76:79], v[28:31], v[84:87]
  ds_read_b64_tr_b16 v[50:51], v64 offset:3840
  v_mfma_f32_32x32x16_bf16 v[224:239], v[32:35], v[16:19], v[224:239]
  ds_read_b64_tr_b16 v[52:53], v65 offset:3072
  v_mfma_f32_32x32x16_bf16 v[240:255], v[32:35], v[20:23], v[240:255]
  ds_read_b64_tr_b16 v[54:55], v65 offset:3840
  v_mfma_f32_16x16x32_bf16 v[88:91], v[76:79], v[32:35], v[88:91]
  s_waitcnt lgkmcnt(0)
  v_mfma_f32_32x32x16_bf16 v[160:175], v[44:47], v[36:39], v[160:175]
  ds_read_b128 v[16:19], v58 offset:0
  ds_read_b64_tr_b16 v[24:25], v60 offset:6144
  v_mfma_f32_32x32x16_bf16 v[176:191], v[44:47], v[40:43], v[176:191]
  ds_read_b64_tr_b16 v[26:27], v60 offset:6912
  v_mfma_f32_32x32x16_bf16 v[192:207], v[48:51], v[36:39], v[192:207]
  ds_read_b128 v[20:23], v58 offset:4096
  v_mfma_f32_32x32x16_bf16 v[208:223], v[48:51], v[40:43], v[208:223]
  ds_read_b64_tr_b16 v[28:29], v61 offset:6144
  ds_read_b64_tr_b16 v[30:31], v61 offset:6912
  v_mfma_f32_32x32x16_bf16 v[224:239], v[52:55], v[36:39], v[224:239]
  ds_read_b64_tr_b16 v[32:33], v62 offset:6144
  v_mfma_f32_32x32x16_bf16 v[240:255], v[52:55], v[40:43], v[240:255]
  ds_read_b64_tr_b16 v[34:35], v62 offset:6912
  s_waitcnt lgkmcnt(0)
  v_mfma_f32_32x32x16_bf16 v[160:175], v[24:27], v[16:19], v[160:175]
  ds_read_b128 v[36:39], v59 offset:0
  ds_read_b64_tr_b16 v[44:45], v63 offset:9216
  v_mfma_f32_32x32x16_bf16 v[176:191], v[24:27], v[20:23], v[176:191]
  ds_read_b64_tr_b16 v[46:47], v63 offset:9984
  v_mfma_f32_16x16x32_bf16 v[80:83], v[76:79], v[24:27], v[80:83]
  v_mfma_f32_32x32x16_bf16 v[192:207], v[28:31], v[16:19], v[192:207]
  ds_read_b128 v[40:43], v59 offset:4096
  v_mfma_f32_32x32x16_bf16 v[208:223], v[28:31], v[20:23], v[208:223]
  ds_read_b64_tr_b16 v[48:49], v64 offset:9216
  v_mfma_f32_16x16x32_bf16 v[84:87], v[76:79], v[28:31], v[84:87]
  ds_read_b64_tr_b16 v[50:51], v64 offset:9984
  v_mfma_f32_32x32x16_bf16 v[224:239], v[32:35], v[16:19], v[224:239]
  ds_read_b64_tr_b16 v[52:53], v65 offset:9216
  v_mfma_f32_32x32x16_bf16 v[240:255], v[32:35], v[20:23], v[240:255]
  ds_read_b64_tr_b16 v[54:55], v65 offset:9984
  v_mfma_f32_16x16x32_bf16 v[88:91], v[76:79], v[32:35], v[88:91]
  s_waitcnt lgkmcnt(0)
  s_barrier
  v_mfma_f32_32x32x16_bf16 v[160:175], v[44:47], v[36:39], v[160:175]
  ds_read_b128 v[16:19], v56 offset:40960
  ds_read_b64_tr_b16 v[24:25], v60 offset:40960
  v_mfma_f32_32x32x16_bf16 v[176:191], v[44:47], v[40:43], v[176:191]
  ds_read_b64_tr_b16 v[26:27], v60 offset:41728
  v_mfma_f32_32x32x16_bf16 v[192:207], v[48:51], v[36:39], v[192:207]
  ds_read_b128 v[20:23], v56 offset:45056
  v_mfma_f32_32x32x16_bf16 v[208:223], v[48:51], v[40:43], v[208:223]
  ds_read_b64_tr_b16 v[28:29], v61 offset:40960
  ds_read_b64_tr_b16 v[30:31], v61 offset:41728
  v_mfma_f32_32x32x16_bf16 v[224:239], v[52:55], v[36:39], v[224:239]
  ds_read_b64_tr_b16 v[32:33], v62 offset:40960
  v_mfma_f32_32x32x16_bf16 v[240:255], v[52:55], v[40:43], v[240:255]
  ds_read_b64_tr_b16 v[34:35], v62 offset:41728
  s_waitcnt lgkmcnt(0)
  v_mfma_f32_32x32x16_bf16 v[160:175], v[24:27], v[16:19], v[160:175]
  ds_read_b128 v[36:39], v57 offset:40960
  ds_read_b64_tr_b16 v[44:45], v63 offset:44032
  v_mfma_f32_32x32x16_bf16 v[176:191], v[24:27], v[20:23], v[176:191]
  ds_read_b64_tr_b16 v[46:47], v63 offset:44800
  v_mfma_f32_16x16x32_bf16 v[80:83], v[76:79], v[24:27], v[80:83]
  v_mfma_f32_32x32x16_bf16 v[192:207], v[28:31], v[16:19], v[192:207]
  ds_read_b128 v[40:43], v57 offset:45056
  v_mfma_f32_32x32x16_bf16 v[208:223], v[28:31], v[20:23], v[208:223]
  ds_read_b64_tr_b16 v[48:49], v64 offset:44032
  v_mfma_f32_16x16x32_bf16 v[84:87], v[76:79], v[28:31], v[84:87]
  ds_read_b64_tr_b16 v[50:51], v64 offset:44800
  v_mfma_f32_32x32x16_bf16 v[224:239], v[32:35], v[16:19], v[224:239]
  ds_read_b64_tr_b16 v[52:53], v65 offset:44032
  v_mfma_f32_32x32x16_bf16 v[240:255], v[32:35], v[20:23], v[240:255]
  ds_read_b64_tr_b16 v[54:55], v65 offset:44800
  v_mfma_f32_16x16x32_bf16 v[88:91], v[76:79], v[32:35], v[88:91]
  s_waitcnt lgkmcnt(0)
  v_mfma_f32_32x32x16_bf16 v[160:175], v[44:47], v[36:39], v[160:175]
  ds_read_b128 v[16:19], v58 offset:40960
  ds_read_b64_tr_b16 v[24:25], v60 offset:47104
  v_mfma_f32_32x32x16_bf16 v[176:191], v[44:47], v[40:43], v[176:191]
  ds_read_b64_tr_b16 v[26:27], v60 offset:47872
  v_mfma_f32_32x32x16_bf16 v[192:207], v[48:51], v[36:39], v[192:207]
  ds_read_b128 v[20:23], v58 offset:45056
  v_mfma_f32_32x32x16_bf16 v[208:223], v[48:51], v[40:43], v[208:223]
  ds_read_b64_tr_b16 v[28:29], v61 offset:47104
  ds_read_b64_tr_b16 v[30:31], v61 offset:47872
  v_mfma_f32_32x32x16_bf16 v[224:239], v[52:55], v[36:39], v[224:239]
  ds_read_b64_tr_b16 v[32:33], v62 offset:47104
  v_mfma_f32_32x32x16_bf16 v[240:255], v[52:55], v[40:43], v[240:255]
  ds_read_b64_tr_b16 v[34:35], v62 offset:47872
  s_waitcnt lgkmcnt(0)
  v_mfma_f32_32x32x16_bf16 v[160:175], v[24:27], v[16:19], v[160:175]
  ds_read_b128 v[36:39], v59 offset:40960
  ds_read_b64_tr_b16 v[44:45], v63 offset:50176
  v_mfma_f32_32x32x16_bf16 v[176:191], v[24:27], v[20:23], v[176:191]
  ds_read_b64_tr_b16 v[46:47], v63 offset:50944
  v_mfma_f32_16x16x32_bf16 v[80:83], v[76:79], v[24:27], v[80:83]
  v_mfma_f32_32x32x16_bf16 v[192:207], v[28:31], v[16:19], v[192:207]
  ds_read_b128 v[40:43], v59 offset:45056
  v_mfma_f32_32x32x16_bf16 v[208:223], v[28:31], v[20:23], v[208:223]
  ds_read_b64_tr_b16 v[48:49], v64 offset:50176
  v_mfma_f32_16x16x32_bf16 v[84:87], v[76:79], v[28:31], v[84:87]
  ds_read_b64_tr_b16 v[50:51], v64 offset:50944
  v_mfma_f32_32x32x16_bf16 v[224:239], v[32:35], v[16:19], v[224:239]
  ds_read_b64_tr_b16 v[52:53], v65 offset:50176
  v_mfma_f32_32x32x16_bf16 v[240:255], v[32:35], v[20:23], v[240:255]
  ds_read_b64_tr_b16 v[54:55], v65 offset:50944
  v_mfma_f32_16x16x32_bf16 v[88:91], v[76:79], v[32:35], v[88:91]
  s_waitcnt lgkmcnt(0)
  v_mfma_f32_32x32x16_bf16 v[160:175], v[44:47], v[36:39], v[160:175]
  v_mfma_f32_32x32x16_bf16 v[176:191], v[44:47], v[40:43], v[176:191]
  v_mfma_f32_32x32x16_bf16 v[192:207], v[48:51], v[36:39], v[192:207]
  v_mfma_f32_32x32x16_bf16 v[208:223], v[48:51], v[40:43], v[208:223]
  v_mfma_f32_32x32x16_bf16 v[224:239], v[52:55], v[36:39], v[224:239]
  v_mfma_f32_32x32x16_bf16 v[240:255], v[52:55], v[40:43], v[240:255]
  s_nop 7
  s_lshl_b32 s86, s84, 1
  s_add_u32 s86, s86, s83
  s_mul_i32 s86, s86, 384
  s_add_u32 s86, s86, 156160
  v_lshlrev_b32 v8, 2, v3
  v_add_u32 v8, s86, v8
  s_mov_b64 s[100:101], exec
  s_mov_b64 exec, 0xffff
  s_cmp_eq_u32 s83, 0
  s_cselect_b32 s87, 0, 256
  v_add_u32 v9, s87, v8
  ds_write_b32 v9, v80
  ds_write_b32 v9, v81 offset:64
  s_cmp_eq_u32 s83, 0
  s_cselect_b32 s87, 128, 128
  v_add_u32 v9, s87, v8
  ds_write_b32 v9, v84
  ds_write_b32 v9, v85 offset:64
  s_cmp_eq_u32 s83, 0
  s_cselect_b32 s87, 256, 0
  v_add_u32 v9, s87, v8
  ds_write_b32 v9, v88
  ds_write_b32 v9, v89 offset:64
  s_mov_b64 exec, s[100:101]
  s_waitcnt lgkmcnt(0)
  s_barrier
  s_setprio 2
  v_mov_b32 v8, 158752
  ds_read_b32 v9, v8
  v_and_b32 v10, 31, v3
  v_lshlrev_b32 v10, 3, v10
  s_lshl_b32 s86, s83, 9
  s_add_u32 s86, s86, 157696
  v_add_u32 v10, s86, v10
  ds_read_b64 v[84:85], v10
  ds_read_b64 v[86:87], v10 offset:256
  v_lshrrev_b32 v13, 5, v3
  v_lshlrev_b32 v13, 4, v13
  s_mul_i32 s86, s84, 768
  s_add_u32 s86, s86, 156160
  v_add_u32 v13, s86, v13
  s_cmp_eq_u32 s83, 0
  s_cselect_b32 s87, 0, 256
  v_add_u32 v8, s87, v13
  ds_read_b128 v[16:19], v8 offset:0
  ds_read_b128 v[20:23], v8 offset:32
  ds_read_b128 v[24:27], v8 offset:64
  ds_read_b128 v[28:31], v8 offset:96
  ds_read_b128 v[64:67], v8 offset:384
  ds_read_b128 v[68:71], v8 offset:416
  ds_read_b128 v[72:75], v8 offset:448
  ds_read_b128 v[76:79], v8 offset:480
  s_cmp_eq_u32 s83, 0
  s_cselect_b32 s87, 128, 128
  v_add_u32 v8, s87, v13
  ds_read_b128 v[32:35], v8 offset:0
  ds_read_b128 v[36:39], v8 offset:32
  ds_read_b128 v[40:43], v8 offset:64
  ds_read_b128 v[44:47], v8 offset:96
  ds_read_b128 v[96:99], v8 offset:384
  ds_read_b128 v[100:103], v8 offset:416
  ds_read_b128 v[104:107], v8 offset:448
  ds_read_b128 v[108:111], v8 offset:480
  s_cmp_eq_u32 s83, 0
  s_cselect_b32 s87, 256, 0
  v_add_u32 v8, s87, v13
  ds_read_b128 v[48:51], v8 offset:0
  ds_read_b128 v[52:55], v8 offset:32
  ds_read_b128 v[56:59], v8 offset:64
  ds_read_b128 v[60:63], v8 offset:96
  ds_read_b128 v[112:115], v8 offset:384
  ds_read_b128 v[116:119], v8 offset:416
  ds_read_b128 v[120:123], v8 offset:448
  ds_read_b128 v[124:127], v8 offset:480
  s_waitcnt lgkmcnt(0)
  v_readfirstlane_b32 s85, v9
  s_mov_b32 s90, 0xbdd2d3e8
  s_mov_b32 s91, 0xc0135761
  v_sub_f32 v144, 0, v84
  v_mul_f32 v152, s91, v85
  v_mul_f32 v11, v85, v85
  v_mul_f32 v12, v11, v85
  v_mul_f32 v148, s90, v12
  v_rcp_f32 v156, v11
  s_nop 1
  v_mov_b32 v145, v144
  v_mov_b32 v153, v152
  v_mov_b32 v149, v148
  v_mov_b32 v157, v156
  v_sub_f32 v146, 0, v86
  v_mul_f32 v154, s91, v87
  v_mul_f32 v11, v87, v87
  v_mul_f32 v12, v11, v87
  v_mul_f32 v150, s90, v12
  v_rcp_f32 v158, v11
  s_nop 1
  v_mov_b32 v147, v146
  v_mov_b32 v155, v154
  v_mov_b32 v151, v150
  v_mov_b32 v159, v158
  v_pk_add_f32 v[16:17], v[16:17], v[64:65]
  v_pk_add_f32 v[18:19], v[18:19], v[66:67]
  v_pk_add_f32 v[20:21], v[20:21], v[68:69]
  v_pk_add_f32 v[22:23], v[22:23], v[70:71]
  v_pk_add_f32 v[24:25], v[24:25], v[72:73]
  v_pk_add_f32 v[26:27], v[26:27], v[74:75]
  v_pk_add_f32 v[28:29], v[28:29], v[76:77]
  v_pk_add_f32 v[30:31], v[30:31], v[78:79]
  v_pk_add_f32 v[32:33], v[32:33], v[96:97]
  v_pk_add_f32 v[34:35], v[34:35], v[98:99]
  v_pk_add_f32 v[36:37], v[36:37], v[100:101]
  v_pk_add_f32 v[38:39], v[38:39], v[102:103]
  v_pk_add_f32 v[40:41], v[40:41], v[104:105]
  v_pk_add_f32 v[42:43], v[42:43], v[106:107]
  v_pk_add_f32 v[44:45], v[44:45], v[108:109]
  v_pk_add_f32 v[46:47], v[46:47], v[110:111]
  v_pk_add_f32 v[48:49], v[48:49], v[112:113]
  v_pk_add_f32 v[50:51], v[50:51], v[114:115]
  v_pk_add_f32 v[52:53], v[52:53], v[116:117]
  v_pk_add_f32 v[54:55], v[54:55], v[118:119]
  v_pk_add_f32 v[56:57], v[56:57], v[120:121]
  v_pk_add_f32 v[58:59], v[58:59], v[122:123]
  v_pk_add_f32 v[60:61], v[60:61], v[124:125]
  v_pk_add_f32 v[62:63], v[62:63], v[126:127]
  v_lshlrev_b32 v12, 4, v3
  s_lshl_b32 s87, s77, 2
  s_lshl_b32 s88, s83, 1
  s_add_u32 s87, s87, s88
  s_mul_i32 s87, s87, 86
  s_lshr_b32 s88, s81, 4
  s_add_u32 s87, s87, s88
  s_add_u32 s87, s87, s84
  s_lshl_b32 s87, s87, 10
  s_add_u32 s94, s87, 4194304
  s_cmp_eq_u32 s83, 0
  s_cselect_b32 s86, 0, 2
  s_cmp_ge_u32 s86, s82
  s_cbranch_scc1 EP_11
  s_lshl_b32 s86, s86, 11
  s_add_u32 s87, s94, s86
  s_add_u32 s88, s87, 88064
  v_pk_fma_f32 v[160:161], v[144:145], v[16:17], v[160:161]
  v_pk_fma_f32 v[162:163], v[144:145], v[18:19], v[162:163]
  v_pk_fma_f32 v[164:165], v[144:145], v[20:21], v[164:165]
  v_pk_fma_f32 v[166:167], v[144:145], v[22:23], v[166:167]
  v_pk_mul_f32 v[128:129], v[160:161], v[160:161]
  v_pk_mul_f32 v[130:131], v[162:163], v[162:163]
  v_pk_mul_f32 v[132:133], v[164:165], v[164:165]
  v_pk_mul_f32 v[134:135], v[166:167], v[166:167]
  v_pk_fma_f32 v[128:129], v[128:129], v[148:149], v[152:153]
  v_pk_fma_f32 v[130:131], v[130:131], v[148:149], v[152:153]
  v_pk_fma_f32 v[132:133], v[132:133], v[148:149], v[152:153]
  v_pk_fma_f32 v[134:135], v[134:135], v[148:149], v[152:153]
  v_pk_mul_f32 v[128:129], v[128:129], v[160:161]
  v_pk_mul_f32 v[130:131], v[130:131], v[162:163]
  v_pk_mul_f32 v[132:133], v[132:133], v[164:165]
  v_pk_mul_f32 v[134:135], v[134:135], v[166:167]
  v_exp_f32 v128, v128
  v_exp_f32 v129, v129
  v_pk_fma_f32 v[168:169], v[144:145], v[24:25], v[168:169]
  v_exp_f32 v130, v130
  v_exp_f32 v131, v131
  v_pk_fma_f32 v[170:171], v[144:145], v[26:27], v[170:171]
  v_exp_f32 v132, v132
  v_exp_f32 v133, v133
  v_pk_fma_f32 v[172:173], v[144:145], v[28:29], v[172:173]
  v_exp_f32 v134, v134
  v_exp_f32 v135, v135
  v_pk_fma_f32 v[174:175], v[144:145], v[30:31], v[174:175]
  v_pk_fma_f32 v[128:129], v[128:129], v[156:157], v[156:157]
  v_pk_fma_f32 v[130:131], v[130:131], v[156:157], v[156:157]
  v_pk_fma_f32 v[132:133], v[132:133], v[156:157], v[156:157]
  v_pk_fma_f32 v[134:135], v[134:135], v[156:157], v[156:157]
  v_rcp_f32 v128, v128
  v_rcp_f32 v129, v129
  v_pk_mul_f32 v[160:161], v[160:161], v[168:169]
  v_rcp_f32 v130, v130
  v_rcp_f32 v131, v131
  v_pk_mul_f32 v[162:163], v[162:163], v[170:171]
  v_rcp_f32 v132, v132
  v_rcp_f32 v133, v133
  v_pk_mul_f32 v[164:165], v[164:165], v[172:173]
  v_rcp_f32 v134, v134
  v_rcp_f32 v135, v135
  v_pk_mul_f32 v[166:167], v[166:167], v[174:175]
  v_pk_mul_f32 v[160:161], v[160:161], v[128:129]
  v_pk_mul_f32 v[162:163], v[162:163], v[130:131]
  v_pk_mul_f32 v[164:165], v[164:165], v[132:133]
  v_pk_mul_f32 v[166:167], v[166:167], v[134:135]
  v_cvt_pk_bf16_f32 v136, v160, v161
  v_cvt_pk_bf16_f32 v137, v162, v163
  v_cvt_pk_bf16_f32 v138, v164, v165
  v_cvt_pk_bf16_f32 v139, v166, v167
  buffer_store_dwordx4 v[136:139], v12, s[24:27], s87 offen sc0 sc1
  v_pk_fma_f32 v[176:177], v[146:147], v[16:17], v[176:177]
  v_pk_fma_f32 v[178:179], v[146:147], v[18:19], v[178:179]
  v_pk_fma_f32 v[180:181], v[146:147], v[20:21], v[180:181]
  v_pk_fma_f32 v[182:183], v[146:147], v[22:23], v[182:183]
  v_pk_mul_f32 v[128:129], v[176:177], v[176:177]
  v_pk_mul_f32 v[130:131], v[178:179], v[178:179]
  v_pk_mul_f32 v[132:133], v[180:181], v[180:181]
  v_pk_mul_f32 v[134:135], v[182:183], v[182:183]
  v_pk_fma_f32 v[128:129], v[128:129], v[150:151], v[154:155]
  v_pk_fma_f32 v[130:131], v[130:131], v[150:151], v[154:155]
  v_pk_fma_f32 v[132:133], v[132:133], v[150:151], v[154:155]
  v_pk_fma_f32 v[134:135], v[134:135], v[150:151], v[154:155]
  v_pk_mul_f32 v[128:129], v[128:129], v[176:177]
  v_pk_mul_f32 v[130:131], v[130:131], v[178:179]
  v_pk_mul_f32 v[132:133], v[132:133], v[180:181]
  v_pk_mul_f32 v[134:135], v[134:135], v[182:183]
  v_exp_f32 v128, v128
  v_exp_f32 v129, v129
  v_pk_fma_f32 v[184:185], v[146:147], v[24:25], v[184:185]
  v_exp_f32 v130, v130
  v_exp_f32 v131, v131
  v_pk_fma_f32 v[186:187], v[146:147], v[26:27], v[186:187]
  v_exp_f32 v132, v132
  v_exp_f32 v133, v133
  v_pk_fma_f32 v[188:189], v[146:147], v[28:29], v[188:189]
  v_exp_f32 v134, v134
  v_exp_f32 v135, v135
  v_pk_fma_f32 v[190:191], v[146:147], v[30:31], v[190:191]
  v_pk_fma_f32 v[128:129], v[128:129], v[158:159], v[158:159]
  v_pk_fma_f32 v[130:131], v[130:131], v[158:159], v[158:159]
  v_pk_fma_f32 v[132:133], v[132:133], v[158:159], v[158:159]
  v_pk_fma_f32 v[134:135], v[134:135], v[158:159], v[158:159]
  v_rcp_f32 v128, v128
  v_rcp_f32 v129, v129
  v_pk_mul_f32 v[176:177], v[176:177], v[184:185]
  v_rcp_f32 v130, v130
  v_rcp_f32 v131, v131
  v_pk_mul_f32 v[178:179], v[178:179], v[186:187]
  v_rcp_f32 v132, v132
  v_rcp_f32 v133, v133
  v_pk_mul_f32 v[180:181], v[180:181], v[188:189]
  v_rcp_f32 v134, v134
  v_rcp_f32 v135, v135
  v_pk_mul_f32 v[182:183], v[182:183], v[190:191]
  v_pk_mul_f32 v[176:177], v[176:177], v[128:129]
  v_pk_mul_f32 v[178:179], v[178:179], v[130:131]
  v_pk_mul_f32 v[180:181], v[180:181], v[132:133]
  v_pk_mul_f32 v[182:183], v[182:183], v[134:135]
  v_cvt_pk_bf16_f32 v140, v176, v177
  v_cvt_pk_bf16_f32 v141, v178, v179
  v_cvt_pk_bf16_f32 v142, v180, v181
  v_cvt_pk_bf16_f32 v143, v182, v183
  buffer_store_dwordx4 v[140:143], v12, s[24:27], s88 offen sc0 sc1
EP_11:
  s_mov_b32 s86, 1
  s_cmp_ge_u32 s86, s82
  s_cbranch_scc1 EP_12
  s_lshl_b32 s86, s86, 11
  s_add_u32 s87, s94, s86
  s_add_u32 s88, s87, 88064
  v_pk_fma_f32 v[192:193], v[144:145], v[32:33], v[192:193]
  v_pk_fma_f32 v[194:195], v[144:145], v[34:35], v[194:195]
  v_pk_fma_f32 v[196:197], v[144:145], v[36:37], v[196:197]
  v_pk_fma_f32 v[198:199], v[144:145], v[38:39], v[198:199]
  v_pk_mul_f32 v[128:129], v[192:193], v[192:193]
  v_pk_mul_f32 v[130:131], v[194:195], v[194:195]
  v_pk_mul_f32 v[132:133], v[196:197], v[196:197]
  v_pk_mul_f32 v[134:135], v[198:199], v[198:199]
  v_pk_fma_f32 v[128:129], v[128:129], v[148:149], v[152:153]
  v_pk_fma_f32 v[130:131], v[130:131], v[148:149], v[152:153]
  v_pk_fma_f32 v[132:133], v[132:133], v[148:149], v[152:153]
  v_pk_fma_f32 v[134:135], v[134:135], v[148:149], v[152:153]
  v_pk_mul_f32 v[128:129], v[128:129], v[192:193]
  v_pk_mul_f32 v[130:131], v[130:131], v[194:195]
  v_pk_mul_f32 v[132:133], v[132:133], v[196:197]
  v_pk_mul_f32 v[134:135], v[134:135], v[198:199]
  v_exp_f32 v128, v128
  v_exp_f32 v129, v129
  v_pk_fma_f32 v[200:201], v[144:145], v[40:41], v[200:201]
  v_exp_f32 v130, v130
  v_exp_f32 v131, v131
  v_pk_fma_f32 v[202:203], v[144:145], v[42:43], v[202:203]
  v_exp_f32 v132, v132
  v_exp_f32 v133, v133
  v_pk_fma_f32 v[204:205], v[144:145], v[44:45], v[204:205]
  v_exp_f32 v134, v134
  v_exp_f32 v135, v135
  v_pk_fma_f32 v[206:207], v[144:145], v[46:47], v[206:207]
  v_pk_fma_f32 v[128:129], v[128:129], v[156:157], v[156:157]
  v_pk_fma_f32 v[130:131], v[130:131], v[156:157], v[156:157]
  v_pk_fma_f32 v[132:133], v[132:133], v[156:157], v[156:157]
  v_pk_fma_f32 v[134:135], v[134:135], v[156:157], v[156:157]
  v_rcp_f32 v128, v128
  v_rcp_f32 v129, v129
  v_pk_mul_f32 v[192:193], v[192:193], v[200:201]
  v_rcp_f32 v130, v130
  v_rcp_f32 v131, v131
  v_pk_mul_f32 v[194:195], v[194:195], v[202:203]
  v_rcp_f32 v132, v132
  v_rcp_f32 v133, v133
  v_pk_mul_f32 v[196:197], v[196:197], v[204:205]
  v_rcp_f32 v134, v134
  v_rcp_f32 v135, v135
  v_pk_mul_f32 v[198:199], v[198:199], v[206:207]
  v_pk_mul_f32 v[192:193], v[192:193], v[128:129]
  v_pk_mul_f32 v[194:195], v[194:195], v[130:131]
  v_pk_mul_f32 v[196:197], v[196:197], v[132:133]
  v_pk_mul_f32 v[198:199], v[198:199], v[134:135]
  v_cvt_pk_bf16_f32 v136, v192, v193
  v_cvt_pk_bf16_f32 v137, v194, v195
  v_cvt_pk_bf16_f32 v138, v196, v197
  v_cvt_pk_bf16_f32 v139, v198, v199
  buffer_store_dwordx4 v[136:139], v12, s[24:27], s87 offen sc0 sc1
  v_pk_fma_f32 v[208:209], v[146:147], v[32:33], v[208:209]
  v_pk_fma_f32 v[210:211], v[146:147], v[34:35], v[210:211]
  v_pk_fma_f32 v[212:213], v[146:147], v[36:37], v[212:213]
  v_pk_fma_f32 v[214:215], v[146:147], v[38:39], v[214:215]
  v_pk_mul_f32 v[128:129], v[208:209], v[208:209]
  v_pk_mul_f32 v[130:131], v[210:211], v[210:211]
  v_pk_mul_f32 v[132:133], v[212:213], v[212:213]
  v_pk_mul_f32 v[134:135], v[214:215], v[214:215]
  v_pk_fma_f32 v[128:129], v[128:129], v[150:151], v[154:155]
  v_pk_fma_f32 v[130:131], v[130:131], v[150:151], v[154:155]
  v_pk_fma_f32 v[132:133], v[132:133], v[150:151], v[154:155]
  v_pk_fma_f32 v[134:135], v[134:135], v[150:151], v[154:155]
  v_pk_mul_f32 v[128:129], v[128:129], v[208:209]
  v_pk_mul_f32 v[130:131], v[130:131], v[210:211]
  v_pk_mul_f32 v[132:133], v[132:133], v[212:213]
  v_pk_mul_f32 v[134:135], v[134:135], v[214:215]
  v_exp_f32 v128, v128
  v_exp_f32 v129, v129
  v_pk_fma_f32 v[216:217], v[146:147], v[40:41], v[216:217]
  v_exp_f32 v130, v130
  v_exp_f32 v131, v131
  v_pk_fma_f32 v[218:219], v[146:147], v[42:43], v[218:219]
  v_exp_f32 v132, v132
  v_exp_f32 v133, v133
  v_pk_fma_f32 v[220:221], v[146:147], v[44:45], v[220:221]
  v_exp_f32 v134, v134
  v_exp_f32 v135, v135
  v_pk_fma_f32 v[222:223], v[146:147], v[46:47], v[222:223]
  v_pk_fma_f32 v[128:129], v[128:129], v[158:159], v[158:159]
  v_pk_fma_f32 v[130:131], v[130:131], v[158:159], v[158:159]
  v_pk_fma_f32 v[132:133], v[132:133], v[158:159], v[158:159]
  v_pk_fma_f32 v[134:135], v[134:135], v[158:159], v[158:159]
  v_rcp_f32 v128, v128
  v_rcp_f32 v129, v129
  v_pk_mul_f32 v[208:209], v[208:209], v[216:217]
  v_rcp_f32 v130, v130
  v_rcp_f32 v131, v131
  v_pk_mul_f32 v[210:211], v[210:211], v[218:219]
  v_rcp_f32 v132, v132
  v_rcp_f32 v133, v133
  v_pk_mul_f32 v[212:213], v[212:213], v[220:221]
  v_rcp_f32 v134, v134
  v_rcp_f32 v135, v135
  v_pk_mul_f32 v[214:215], v[214:215], v[222:223]
  v_pk_mul_f32 v[208:209], v[208:209], v[128:129]
  v_pk_mul_f32 v[210:211], v[210:211], v[130:131]
  v_pk_mul_f32 v[212:213], v[212:213], v[132:133]
  v_pk_mul_f32 v[214:215], v[214:215], v[134:135]
  v_cvt_pk_bf16_f32 v140, v208, v209
  v_cvt_pk_bf16_f32 v141, v210, v211
  v_cvt_pk_bf16_f32 v142, v212, v213
  v_cvt_pk_bf16_f32 v143, v214, v215
  buffer_store_dwordx4 v[140:143], v12, s[24:27], s88 offen sc0 sc1
EP_12:
  s_cmp_eq_u32 s83, 0
  s_cselect_b32 s86, 2, 0
  s_cmp_ge_u32 s86, s82
  s_cbranch_scc1 EP_13
  s_lshl_b32 s86, s86, 11
  s_add_u32 s87, s94, s86
  s_add_u32 s88, s87, 88064
  v_pk_fma_f32 v[224:225], v[144:145], v[48:49], v[224:225]
  v_pk_fma_f32 v[226:227], v[144:145], v[50:51], v[226:227]
  v_pk_fma_f32 v[228:229], v[144:145], v[52:53], v[228:229]
  v_pk_fma_f32 v[230:231], v[144:145], v[54:55], v[230:231]
  v_pk_mul_f32 v[128:129], v[224:225], v[224:225]
  v_pk_mul_f32 v[130:131], v[226:227], v[226:227]
  v_pk_mul_f32 v[132:133], v[228:229], v[228:229]
  v_pk_mul_f32 v[134:135], v[230:231], v[230:231]
  v_pk_fma_f32 v[128:129], v[128:129], v[148:149], v[152:153]
  v_pk_fma_f32 v[130:131], v[130:131], v[148:149], v[152:153]
  v_pk_fma_f32 v[132:133], v[132:133], v[148:149], v[152:153]
  v_pk_fma_f32 v[134:135], v[134:135], v[148:149], v[152:153]
  v_pk_mul_f32 v[128:129], v[128:129], v[224:225]
  v_pk_mul_f32 v[130:131], v[130:131], v[226:227]
  v_pk_mul_f32 v[132:133], v[132:133], v[228:229]
  v_pk_mul_f32 v[134:135], v[134:135], v[230:231]
  v_exp_f32 v128, v128
  v_exp_f32 v129, v129
  v_pk_fma_f32 v[232:233], v[144:145], v[56:57], v[232:233]
  v_exp_f32 v130, v130
  v_exp_f32 v131, v131
  v_pk_fma_f32 v[234:235], v[144:145], v[58:59], v[234:235]
  v_exp_f32 v132, v132
  v_exp_f32 v133, v133
  v_pk_fma_f32 v[236:237], v[144:145], v[60:61], v[236:237]
  v_exp_f32 v134, v134
  v_exp_f32 v135, v135
  v_pk_fma_f32 v[238:239], v[144:145], v[62:63], v[238:239]
  v_pk_fma_f32 v[128:129], v[128:129], v[156:157], v[156:157]
  v_pk_fma_f32 v[130:131], v[130:131], v[156:157], v[156:157]
  v_pk_fma_f32 v[132:133], v[132:133], v[156:157], v[156:157]
  v_pk_fma_f32 v[134:135], v[134:135], v[156:157], v[156:157]
  v_rcp_f32 v128, v128
  v_rcp_f32 v129, v129
  v_pk_mul_f32 v[224:225], v[224:225], v[232:233]
  v_rcp_f32 v130, v130
  v_rcp_f32 v131, v131
  v_pk_mul_f32 v[226:227], v[226:227], v[234:235]
  v_rcp_f32 v132, v132
  v_rcp_f32 v133, v133
  v_pk_mul_f32 v[228:229], v[228:229], v[236:237]
  v_rcp_f32 v134, v134
  v_rcp_f32 v135, v135
  v_pk_mul_f32 v[230:231], v[230:231], v[238:239]
  v_pk_mul_f32 v[224:225], v[224:225], v[128:129]
  v_pk_mul_f32 v[226:227], v[226:227], v[130:131]
  v_pk_mul_f32 v[228:229], v[228:229], v[132:133]
  v_pk_mul_f32 v[230:231], v[230:231], v[134:135]
  v_cvt_pk_bf16_f32 v136, v224, v225
  v_cvt_pk_bf16_f32 v137, v226, v227
  v_cvt_pk_bf16_f32 v138, v228, v229
  v_cvt_pk_bf16_f32 v139, v230, v231
  buffer_store_dwordx4 v[136:139], v12, s[24:27], s87 offen sc0 sc1
  v_pk_fma_f32 v[240:241], v[146:147], v[48:49], v[240:241]
  v_pk_fma_f32 v[242:243], v[146:147], v[50:51], v[242:243]
  v_pk_fma_f32 v[244:245], v[146:147], v[52:53], v[244:245]
  v_pk_fma_f32 v[246:247], v[146:147], v[54:55], v[246:247]
  v_pk_mul_f32 v[128:129], v[240:241], v[240:241]
  v_pk_mul_f32 v[130:131], v[242:243], v[242:243]
  v_pk_mul_f32 v[132:133], v[244:245], v[244:245]
  v_pk_mul_f32 v[134:135], v[246:247], v[246:247]
  v_pk_fma_f32 v[128:129], v[128:129], v[150:151], v[154:155]
  v_pk_fma_f32 v[130:131], v[130:131], v[150:151], v[154:155]
  v_pk_fma_f32 v[132:133], v[132:133], v[150:151], v[154:155]
  v_pk_fma_f32 v[134:135], v[134:135], v[150:151], v[154:155]
  v_pk_mul_f32 v[128:129], v[128:129], v[240:241]
  v_pk_mul_f32 v[130:131], v[130:131], v[242:243]
  v_pk_mul_f32 v[132:133], v[132:133], v[244:245]
  v_pk_mul_f32 v[134:135], v[134:135], v[246:247]
  v_exp_f32 v128, v128
  v_exp_f32 v129, v129
  v_pk_fma_f32 v[248:249], v[146:147], v[56:57], v[248:249]
  v_exp_f32 v130, v130
  v_exp_f32 v131, v131
  v_pk_fma_f32 v[250:251], v[146:147], v[58:59], v[250:251]
  v_exp_f32 v132, v132
  v_exp_f32 v133, v133
  v_pk_fma_f32 v[252:253], v[146:147], v[60:61], v[252:253]
  v_exp_f32 v134, v134
  v_exp_f32 v135, v135
  v_pk_fma_f32 v[254:255], v[146:147], v[62:63], v[254:255]
  v_pk_fma_f32 v[128:129], v[128:129], v[158:159], v[158:159]
  v_pk_fma_f32 v[130:131], v[130:131], v[158:159], v[158:159]
  v_pk_fma_f32 v[132:133], v[132:133], v[158:159], v[158:159]
  v_pk_fma_f32 v[134:135], v[134:135], v[158:159], v[158:159]
  v_rcp_f32 v128, v128
  v_rcp_f32 v129, v129
  v_pk_mul_f32 v[240:241], v[240:241], v[248:249]
  v_rcp_f32 v130, v130
  v_rcp_f32 v131, v131
  v_pk_mul_f32 v[242:243], v[242:243], v[250:251]
  v_rcp_f32 v132, v132
  v_rcp_f32 v133, v133
  v_pk_mul_f32 v[244:245], v[244:245], v[252:253]
  v_rcp_f32 v134, v134
  v_rcp_f32 v135, v135
  v_pk_mul_f32 v[246:247], v[246:247], v[254:255]
  v_pk_mul_f32 v[240:241], v[240:241], v[128:129]
  v_pk_mul_f32 v[242:243], v[242:243], v[130:131]
  v_pk_mul_f32 v[244:245], v[244:245], v[132:133]
  v_pk_mul_f32 v[246:247], v[246:247], v[134:135]
  v_cvt_pk_bf16_f32 v140, v240, v241
  v_cvt_pk_bf16_f32 v141, v242, v243
  v_cvt_pk_bf16_f32 v142, v244, v245
  v_cvt_pk_bf16_f32 v143, v246, v247
  buffer_store_dwordx4 v[140:143], v12, s[24:27], s88 offen sc0 sc1
EP_13:
  s_lshl_b32 s86, s76, 2
  s_add_u32 s86, s86, 158768
  v_mov_b32 v8, s86
  v_mov_b32 v9, 1
  ds_write_b32 v8, v9
  s_mul_i32 s45, s80, 3
  s_mul_i32 s92, s76, 22
  s_cmp_eq_u32 s76, 3
  s_cselect_b32 s87, 1, 0
  s_sub_u32 s92, s92, s87
  s_cmp_lt_u32 s76, 2
  s_cselect_b32 s93, 22, 21
  s_mul_i32 s94, s76, 10240
  s_add_u32 s95, s94, 0
  s_add_u32 s94, s94, 81920
  s_lshl_b32 s96, s76, 11
  s_add_u32 s96, s96, 68608
  v_lshrrev_b32 v8, 3, v3
  v_and_b32 v9, 7, v3
  v_bfe_u32 v10, v3, 4, 1
  v_lshlrev_b32 v10, 2, v10
  v_xor_b32 v9, v9, v10
  v_lshlrev_b32 v9, 4, v9
  v_lshl_add_u32 v9, v8, 10, v9
  s_lshl_b32 s87, s80, 7
  v_add_u32 v255, s87, v9
  v_lshrrev_b32 v8, 5, v3
  v_bfe_u32 v9, v3, 2, 2
  v_lshl_add_u32 v8, v8, 2, v9
  v_lshlrev_b32 v8, 7, v8
  v_bfe_u32 v10, v3, 4, 1
  v_bfe_u32 v11, v3, 1, 1
  v_lshl_add_u32 v10, v10, 1, v11
  v_lshlrev_b32 v10, 4, v10
  v_and_b32 v11, 1, v3
  v_lshl_add_u32 v10, v11, 3, v10
  v_add_u32 v8, v8, v10
  v_bfe_u32 v9, v3, 3, 1
  v_lshlrev_b32 v9, 6, v9
  v_add_u32 v10, v8, v9
  v_xor_b32 v9, 64, v9
  v_add_u32 v11, v8, v9
  v_add_u32 v248, s94, v10
  v_add_u32 v249, s94, v11
  v_add_u32 v250, s95, v10
  v_add_u32 v251, s95, v11
  v_add_u32 v252, s96, v10
  v_add_u32 v253, s96, v11
  v_lshlrev_b32 v254, 4, v3
  s_mov_b32 s99, 0x20000000
  s_waitcnt vmcnt(0)
  s_lshl_b32 s86, s77, 8
  s_lshl_b32 s87, s78, 4
  s_lshl_b32 s88, s76, 2
  s_add_u32 s86, s86, s87
  s_add_u32 s86, s86, s88
  s_add_u32 s86, s86, 13639680
  v_mov_b32 v8, s85
  s_mov_b64 s[100:101], exec
  s_mov_b64 exec, 1
  buffer_store_dword v8, off, s[24:27], s86 sc0 sc1
  s_mov_b64 exec, s[100:101]
  s_lshl_b32 s86, s76, 2
  s_add_u32 s86, s86, 158736
  v_mov_b32 v9, s86
  s_mov_b32 s89, 0x200000
LS_14:
  ds_read_b32 v8, v9
  s_waitcnt lgkmcnt(0)
  v_readfirstlane_b32 s88, v8
  s_nop 3
  s_cmp_eq_u32 s88, 1
  s_cbranch_scc1 LSD_15
  s_sub_u32 s89, s89, 1
  s_cmp_eq_u32 s89, 0
  s_cbranch_scc1 LSD_15
  s_sleep 1
  s_branch LS_14
LSD_15:
  ds_read_b64_tr_b16 v[80:81], v248 offset:0
  ds_read_b64_tr_b16 v[82:83], v248 offset:1024
  ds_read_b64_tr_b16 v[84:85], v249 offset:0
  ds_read_b64_tr_b16 v[86:87], v249 offset:1024
  ds_read_b64_tr_b16 v[88:89], v248 offset:2048
  ds_read_b64_tr_b16 v[90:91], v248 offset:3072
  ds_read_b64_tr_b16 v[92:93], v249 offset:2048
  ds_read_b64_tr_b16 v[94:95], v249 offset:3072
  ds_read_b64_tr_b16 v[96:97], v248 offset:4096
  ds_read_b64_tr_b16 v[98:99], v248 offset:5120
  ds_read_b64_tr_b16 v[100:101], v249 offset:4096
  ds_read_b64_tr_b16 v[102:103], v249 offset:5120
  s_waitcnt lgkmcnt(4)
  ds_read_b64_tr_b16 v[104:105], v248 offset:6144
  ds_read_b64_tr_b16 v[106:107], v248 offset:7168
  ds_read_b64_tr_b16 v[108:109], v249 offset:6144
  ds_read_b64_tr_b16 v[110:111], v249 offset:7168
  ds_read_b64_tr_b16 v[112:113], v248 offset:8192
  ds_read_b64_tr_b16 v[114:115], v248 offset:9216
  ds_read_b64_tr_b16 v[116:117], v249 offset:8192
  ds_read_b64_tr_b16 v[118:119], v249 offset:9216
  ds_read_b64_tr_b16 v[120:121], v250 offset:0
  ds_read_b64_tr_b16 v[122:123], v250 offset:1024
  ds_read_b64_tr_b16 v[124:125], v251 offset:0
  ds_read_b64_tr_b16 v[126:127], v251 offset:1024
  s_waitcnt lgkmcnt(4)
  ds_read_b64_tr_b16 v[128:129], v250 offset:2048
  ds_read_b64_tr_b16 v[130:131], v250 offset:3072
  ds_read_b64_tr_b16 v[132:133], v251 offset:2048
  ds_read_b64_tr_b16 v[134:135], v251 offset:3072
  ds_read_b64_tr_b16 v[136:137], v250 offset:4096
  ds_read_b64_tr_b16 v[138:139], v250 offset:5120
  ds_read_b64_tr_b16 v[140:141], v251 offset:4096
  ds_read_b64_tr_b16 v[142:143], v251 offset:5120
  ds_read_b64_tr_b16 v[144:145], v250 offset:6144
  ds_read_b64_tr_b16 v[146:147], v250 offset:7168
  ds_read_b64_tr_b16 v[148:149], v251 offset:6144
  ds_read_b64_tr_b16 v[150:151], v251 offset:7168
  s_waitcnt lgkmcnt(4)
  ds_read_b64_tr_b16 v[152:153], v250 offset:8192
  ds_read_b64_tr_b16 v[154:155], v250 offset:9216
  ds_read_b64_tr_b16 v[156:157], v251 offset:8192
  ds_read_b64_tr_b16 v[158:159], v251 offset:9216
  ds_read_b64_tr_b16 v[160:161], v252 offset:0
  ds_read_b64_tr_b16 v[162:163], v252 offset:1024
  ds_read_b64_tr_b16 v[164:165], v253 offset:0
  ds_read_b64_tr_b16 v[166:167], v253 offset:1024
  s_waitcnt lgkmcnt(0)
  s_add_u32 s44, s45, 11
  s_cmp_ge_u32 s44, 22
  s_cselect_b32 s91, 22, 0
  s_sub_u32 s44, s44, s91
  s_cmp_lt_u32 s44, s93
  s_cselect_b32 s91, 1, 0
  s_add_u32 s44, s44, s92
  s_lshl_b32 s44, s44, 14
  s_cmp_eq_u32 s91, 1
  s_cselect_b32 s44, s44, s99
  s_add_u32 m0, s94, 0
  s_nop 0
  buffer_load_dwordx4 v255, s[20:23], s44 offen lds
  s_add_u32 m0, s94, 1024
  s_add_u32 s44, s44, 8192
  buffer_load_dwordx4 v255, s[20:23], s44 offen lds
  s_add_u32 s44, s45, 12
  s_cmp_ge_u32 s44, 22
  s_cselect_b32 s91, 22, 0
  s_sub_u32 s44, s44, s91
  s_cmp_lt_u32 s44, s93
  s_cselect_b32 s91, 1, 0
  s_add_u32 s44, s44, s92
  s_lshl_b32 s44, s44, 14
  s_cmp_eq_u32 s91, 1
  s_cselect_b32 s44, s44, s99
  s_add_u32 m0, s94, 2048
  s_nop 0
  buffer_load_dwordx4 v255, s[20:23], s44 offen lds
  s_add_u32 m0, s94, 3072
  s_add_u32 s44, s44, 8192
  buffer_load_dwordx4 v255, s[20:23], s44 offen lds
  s_add_u32 s44, s45, 13
  s_cmp_ge_u32 s44, 22
  s_cselect_b32 s91, 22, 0
  s_sub_u32 s44, s44, s91
  s_cmp_lt_u32 s44, s93
  s_cselect_b32 s91, 1, 0
  s_add_u32 s44, s44, s92
  s_lshl_b32 s44, s44, 14
  s_cmp_eq_u32 s91, 1
  s_cselect_b32 s44, s44, s99
  s_add_u32 m0, s94, 4096
  s_nop 0
  buffer_load_dwordx4 v255, s[20:23], s44 offen lds
  s_add_u32 m0, s94, 5120
  s_add_u32 s44, s44, 8192
  buffer_load_dwordx4 v255, s[20:23], s44 offen lds
  s_add_u32 s44, s45, 14
  s_cmp_ge_u32 s44, 22
  s_cselect_b32 s91, 22, 0
  s_sub_u32 s44, s44, s91
  s_cmp_lt_u32 s44, s93
  s_cselect_b32 s91, 1, 0
  s_add_u32 s44, s44, s92
  s_lshl_b32 s44, s44, 14
  s_cmp_eq_u32 s91, 1
  s_cselect_b32 s44, s44, s99
  s_add_u32 m0, s94, 6144
  s_nop 0
  buffer_load_dwordx4 v255, s[20:23], s44 offen lds
  s_add_u32 m0, s94, 7168
  s_add_u32 s44, s44, 8192
  buffer_load_dwordx4 v255, s[20:23], s44 offen lds
  s_add_u32 s44, s45, 15
  s_cmp_ge_u32 s44, 22
  s_cselect_b32 s91, 22, 0
  s_sub_u32 s44, s44, s91
  s_cmp_lt_u32 s44, s93
  s_cselect_b32 s91, 1, 0
  s_add_u32 s44, s44, s92
  s_lshl_b32 s44, s44, 14
  s_cmp_eq_u32 s91, 1
  s_cselect_b32 s44, s44, s99
  s_add_u32 m0, s94, 8192
  s_nop 0
  buffer_load_dwordx4 v255, s[20:23], s44 offen lds
  s_add_u32 m0, s94, 9216
  s_add_u32 s44, s44, 8192
  buffer_load_dwordx4 v255, s[20:23], s44 offen lds
  s_add_u32 s44, s45, 16
  s_cmp_ge_u32 s44, 22
  s_cselect_b32 s91, 22, 0
  s_sub_u32 s44, s44, s91
  s_cmp_lt_u32 s44, s93
  s_cselect_b32 s91, 1, 0
  s_add_u32 s44, s44, s92
  s_lshl_b32 s44, s44, 14
  s_cmp_eq_u32 s91, 1
  s_cselect_b32 s44, s44, s99
  s_add_u32 m0, s95, 0
  s_nop 0
  buffer_load_dwordx4 v255, s[20:23], s44 offen lds
  s_add_u32 m0, s95, 1024
  s_add_u32 s44, s44, 8192
  buffer_load_dwordx4 v255, s[20:23], s44 offen lds
  s_add_u32 s44, s45, 17
  s_cmp_ge_u32 s44, 22
  s_cselect_b32 s91, 22, 0
  s_sub_u32 s44, s44, s91
  s_cmp_lt_u32 s44, s93
  s_cselect_b32 s91, 1, 0
  s_add_u32 s44, s44, s92
  s_lshl_b32 s44, s44, 14
  s_cmp_eq_u32 s91, 1
  s_cselect_b32 s44, s44, s99
  s_add_u32 m0, s95, 2048
  s_nop 0
  buffer_load_dwordx4 v255, s[20:23], s44 offen lds
  s_add_u32 m0, s95, 3072
  s_add_u32 s44, s44, 8192
  buffer_load_dwordx4 v255, s[20:23], s44 offen lds
  s_add_u32 s44, s45, 18
  s_cmp_ge_u32 s44, 22
  s_cselect_b32 s91, 22, 0
  s_sub_u32 s44, s44, s91
  s_cmp_lt_u32 s44, s93
  s_cselect_b32 s91, 1, 0
  s_add_u32 s44, s44, s92
  s_lshl_b32 s44, s44, 14
  s_cmp_eq_u32 s91, 1
  s_cselect_b32 s44, s44, s99
  s_add_u32 m0, s95, 4096
  s_nop 0
  buffer_load_dwordx4 v255, s[20:23], s44 offen lds
  s_add_u32 m0, s95, 5120
  s_add_u32 s44, s44, 8192
  buffer_load_dwordx4 v255, s[20:23], s44 offen lds
  s_add_u32 s44, s45, 19
  s_cmp_ge_u32 s44, 22
  s_cselect_b32 s91, 22, 0
  s_sub_u32 s44, s44, s91
  s_cmp_lt_u32 s44, s93
  s_cselect_b32 s91, 1, 0
  s_add_u32 s44, s44, s92
  s_lshl_b32 s44, s44, 14
  s_cmp_eq_u32 s91, 1
  s_cselect_b32 s44, s44, s99
  s_add_u32 m0, s95, 6144
  s_nop 0
  buffer_load_dwordx4 v255, s[20:23], s44 offen lds
  s_add_u32 m0, s95, 7168
  s_add_u32 s44, s44, 8192
  buffer_load_dwordx4 v255, s[20:23], s44 offen lds
  s_add_u32 s44, s45, 20
  s_cmp_ge_u32 s44, 22
  s_cselect_b32 s91, 22, 0
  s_sub_u32 s44, s44, s91
  s_cmp_lt_u32 s44, s93
  s_cselect_b32 s91, 1, 0
  s_add_u32 s44, s44, s92
  s_lshl_b32 s44, s44, 14
  s_cmp_eq_u32 s91, 1
  s_cselect_b32 s44, s44, s99
  s_add_u32 m0, s95, 8192
  s_nop 0
  buffer_load_dwordx4 v255, s[20:23], s44 offen lds
  s_add_u32 m0, s95, 9216
  s_add_u32 s44, s44, 8192
  buffer_load_dwordx4 v255, s[20:23], s44 offen lds
  s_add_u32 s44, s45, 21
  s_cmp_ge_u32 s44, 22
  s_cselect_b32 s91, 22, 0
  s_sub_u32 s44, s44, s91
  s_cmp_lt_u32 s44, s93
  s_cselect_b32 s91, 1, 0
  s_add_u32 s44, s44, s92
  s_lshl_b32 s44, s44, 14
  s_cmp_eq_u32 s91, 1
  s_cselect_b32 s44, s44, s99
  s_add_u32 m0, s96, 0
  s_nop 0
  buffer_load_dwordx4 v255, s[20:23], s44 offen lds
  s_add_u32 m0, s96, 1024
  s_add_u32 s44, s44, 8192
  buffer_load_dwordx4 v255, s[20:23], s44 offen lds
  v_mov_b32 v176, 0
  v_mov_b32 v177, 0
  v_mov_b32 v178, 0
  v_mov_b32 v179, 0
  v_mov_b32 v180, 0
  v_mov_b32 v181, 0
  v_mov_b32 v182, 0
  v_mov_b32 v183, 0
  v_mov_b32 v184, 0
  v_mov_b32 v185, 0
  v_mov_b32 v186, 0
  v_mov_b32 v187, 0
  v_mov_b32 v188, 0
  v_mov_b32 v189, 0
  v_mov_b32 v190, 0
  v_mov_b32 v191, 0
  v_mov_b32 v192, 0
  v_mov_b32 v193, 0
  v_mov_b32 v194, 0
  v_mov_b32 v195, 0
  v_mov_b32 v196, 0
  v_mov_b32 v197, 0
  v_mov_b32 v198, 0
  v_mov_b32 v199, 0
  v_mov_b32 v200, 0
  v_mov_b32 v201, 0
  v_mov_b32 v202, 0
  v_mov_b32 v203, 0
  v_mov_b32 v204, 0
  v_mov_b32 v205, 0
  v_mov_b32 v206, 0
  v_mov_b32 v207, 0
  v_mov_b32 v208, 0
  v_mov_b32 v209, 0
  v_mov_b32 v210, 0
  v_mov_b32 v211, 0
  v_mov_b32 v212, 0
  v_mov_b32 v213, 0
  v_mov_b32 v214, 0
  v_mov_b32 v215, 0
  v_mov_b32 v216, 0
  v_mov_b32 v217, 0
  v_mov_b32 v218, 0
  v_mov_b32 v219, 0
  v_mov_b32 v220, 0
  v_mov_b32 v221, 0
  v_mov_b32 v222, 0
  v_mov_b32 v223, 0
  v_mov_b32 v224, 0
  v_mov_b32 v225, 0
  v_mov_b32 v226, 0
  v_mov_b32 v227, 0
  v_mov_b32 v228, 0
  v_mov_b32 v229, 0
  v_mov_b32 v230, 0
  v_mov_b32 v231, 0
  v_mov_b32 v232, 0
  v_mov_b32 v233, 0
  v_mov_b32 v234, 0
  v_mov_b32 v235, 0
  v_mov_b32 v236, 0
  v_mov_b32 v237, 0
  v_mov_b32 v238, 0
  v_mov_b32 v239, 0
  s_lshr_b32 s86, s79, 1
  s_lshl_b32 s86, s86, 8
  s_add_u32 s86, s86, 13639680
  s_cmp_lg_u32 s76, 0
  s_cbranch_scc1 HP_16
  s_mov_b32 s89, 0x40000
POLL_18:
  v_lshlrev_b32 v13, 2, v3
  buffer_load_dword v9, v13, s[24:27], s86 offen sc1
  s_waitcnt vmcnt(0)
  v_cmp_eq_u32 vcc, s85, v9
  s_nop 1
  s_cmp_eq_u64 vcc, -1
  s_cbranch_scc1 POLLD_19
  s_sub_u32 s89, s89, 1
  s_cmp_eq_u32 s89, 0
  s_cbranch_scc1 POLLD_19
  s_sleep 2
  s_branch POLL_18
POLLD_19:
  v_mov_b32 v8, 158792
  v_mov_b32 v9, 1
  ds_write_b32 v8, v9
  s_branch HP_17
HP_16:
  s_mov_b32 s86, 158792
  v_mov_b32 v8, s86
  s_mov_b32 s89, 0x200000
LS_20:
  ds_read_b32 v9, v8
  s_waitcnt lgkmcnt(0)
  v_readfirstlane_b32 s88, v9
  s_nop 3
  s_cmp_eq_u32 s88, 1
  s_cbranch_scc1 LSD_21
  s_sub_u32 s89, s89, 1
  s_cmp_eq_u32 s89, 0
  s_cbranch_scc1 LSD_21
  s_sleep 1
  s_branch LS_20
LSD_21:
  s_waitcnt vmcnt(0)
HP_17:
  s_lshl_b32 s86, s79, 1
  s_mul_i32 s86, s86, 86
  s_add_u32 s86, s86, s92
  s_lshl_b32 s86, s86, 10
  s_add_u32 s46, s86, 4194304
  s_add_u32 s97, s45, 0
  s_cmp_ge_u32 s97, 22
  s_cselect_b32 s91, 22, 0
  s_sub_u32 s97, s97, s91
  s_cmp_lt_u32 s97, s93
  s_cselect_b32 s91, 1, 0
  s_lshl_b32 s97, s97, 10
  s_add_u32 s97, s97, s46
  s_cmp_eq_u32 s91, 1
  s_cselect_b32 s97, s97, s99
  s_add_u32 s98, s97, 88064
  buffer_load_dwordx4 v[16:19], v254, s[24:27], s97 offen sc1
  buffer_load_dwordx4 v[20:23], v254, s[24:27], s98 offen sc1
  s_add_u32 s97, s45, 1
  s_cmp_ge_u32 s97, 22
  s_cselect_b32 s91, 22, 0
  s_sub_u32 s97, s97, s91
  s_cmp_lt_u32 s97, s93
  s_cselect_b32 s91, 1, 0
  s_lshl_b32 s97, s97, 10
  s_add_u32 s97, s97, s46
  s_cmp_eq_u32 s91, 1
  s_cselect_b32 s97, s97, s99
  s_add_u32 s98, s97, 88064
  buffer_load_dwordx4 v[24:27], v254, s[24:27], s97 offen sc1
  buffer_load_dwordx4 v[28:31], v254, s[24:27], s98 offen sc1
  s_add_u32 s97, s45, 2
  s_cmp_ge_u32 s97, 22
  s_cselect_b32 s91, 22, 0
  s_sub_u32 s97, s97, s91
  s_cmp_lt_u32 s97, s93
  s_cselect_b32 s91, 1, 0
  s_lshl_b32 s97, s97, 10
  s_add_u32 s97, s97, s46
  s_cmp_eq_u32 s91, 1
  s_cselect_b32 s97, s97, s99
  s_add_u32 s98, s97, 88064
  buffer_load_dwordx4 v[32:35], v254, s[24:27], s97 offen sc1
  buffer_load_dwordx4 v[36:39], v254, s[24:27], s98 offen sc1
  s_add_u32 s97, s45, 3
  s_cmp_ge_u32 s97, 22
  s_cselect_b32 s91, 22, 0
  s_sub_u32 s97, s97, s91
  s_cmp_lt_u32 s97, s93
  s_cselect_b32 s91, 1, 0
  s_lshl_b32 s97, s97, 10
  s_add_u32 s97, s97, s46
  s_cmp_eq_u32 s91, 1
  s_cselect_b32 s97, s97, s99
  s_add_u32 s98, s97, 88064
  buffer_load_dwordx4 v[40:43], v254, s[24:27], s97 offen sc1
  buffer_load_dwordx4 v[44:47], v254, s[24:27], s98 offen sc1
  s_add_u32 s97, s45, 4
  s_cmp_ge_u32 s97, 22
  s_cselect_b32 s91, 22, 0
  s_sub_u32 s97, s97, s91
  s_cmp_lt_u32 s97, s93
  s_cselect_b32 s91, 1, 0
  s_lshl_b32 s97, s97, 10
  s_add_u32 s97, s97, s46
  s_cmp_eq_u32 s91, 1
  s_cselect_b32 s97, s97, s99
  s_add_u32 s98, s97, 88064
  buffer_load_dwordx4 v[48:51], v254, s[24:27], s97 offen sc1
  buffer_load_dwordx4 v[52:55], v254, s[24:27], s98 offen sc1
  s_add_u32 s97, s45, 5
  s_cmp_ge_u32 s97, 22
  s_cselect_b32 s91, 22, 0
  s_sub_u32 s97, s97, s91
  s_cmp_lt_u32 s97, s93
  s_cselect_b32 s91, 1, 0
  s_lshl_b32 s97, s97, 10
  s_add_u32 s97, s97, s46
  s_cmp_eq_u32 s91, 1
  s_cselect_b32 s97, s97, s99
  s_add_u32 s98, s97, 88064
  buffer_load_dwordx4 v[56:59], v254, s[24:27], s97 offen sc1
  buffer_load_dwordx4 v[60:63], v254, s[24:27], s98 offen sc1
  s_add_u32 s97, s45, 6
  s_cmp_ge_u32 s97, 22
  s_cselect_b32 s91, 22, 0
  s_sub_u32 s97, s97, s91
  s_cmp_lt_u32 s97, s93
  s_cselect_b32 s91, 1, 0
  s_lshl_b32 s97, s97, 10
  s_add_u32 s97, s97, s46
  s_cmp_eq_u32 s91, 1
  s_cselect_b32 s97, s97, s99
  s_add_u32 s98, s97, 88064
  buffer_load_dwordx4 v[64:67], v254, s[24:27], s97 offen sc1
  buffer_load_dwordx4 v[68:71], v254, s[24:27], s98 offen sc1
  s_add_u32 s97, s45, 7
  s_cmp_ge_u32 s97, 22
  s_cselect_b32 s91, 22, 0
  s_sub_u32 s97, s97, s91
  s_cmp_lt_u32 s97, s93
  s_cselect_b32 s91, 1, 0
  s_lshl_b32 s97, s97, 10
  s_add_u32 s97, s97, s46
  s_cmp_eq_u32 s91, 1
  s_cselect_b32 s97, s97, s99
  s_add_u32 s98, s97, 88064
  buffer_load_dwordx4 v[72:75], v254, s[24:27], s97 offen sc1
  buffer_load_dwordx4 v[76:79], v254, s[24:27], s98 offen sc1
  s_waitcnt vmcnt(14)
  v_mfma_f32_32x32x16_bf16 v[176:191], v[80:83], v[16:19], v[176:191]
  v_mfma_f32_32x32x16_bf16 v[192:207], v[80:83], v[20:23], v[192:207]
  v_mfma_f32_32x32x16_bf16 v[208:223], v[84:87], v[16:19], v[208:223]
  v_mfma_f32_32x32x16_bf16 v[224:239], v[84:87], v[20:23], v[224:239]
  s_add_u32 s97, s45, 8
  s_cmp_ge_u32 s97, 22
  s_cselect_b32 s91, 22, 0
  s_sub_u32 s97, s97, s91
  s_cmp_lt_u32 s97, s93
  s_cselect_b32 s91, 1, 0
  s_lshl_b32 s97, s97, 10
  s_add_u32 s97, s97, s46
  s_cmp_eq_u32 s91, 1
  s_cselect_b32 s97, s97, s99
  s_add_u32 s98, s97, 88064
  buffer_load_dwordx4 v[16:19], v254, s[24:27], s97 offen sc1
  buffer_load_dwordx4 v[20:23], v254, s[24:27], s98 offen sc1
  s_waitcnt vmcnt(14)
  v_mfma_f32_32x32x16_bf16 v[176:191], v[88:91], v[24:27], v[176:191]
  v_mfma_f32_32x32x16_bf16 v[192:207], v[88:91], v[28:31], v[192:207]
  v_mfma_f32_32x32x16_bf16 v[208:223], v[92:95], v[24:27], v[208:223]
  v_mfma_f32_32x32x16_bf16 v[224:239], v[92:95], v[28:31], v[224:239]
  s_add_u32 s97, s45, 9
  s_cmp_ge_u32 s97, 22
  s_cselect_b32 s91, 22, 0
  s_sub_u32 s97, s97, s91
  s_cmp_lt_u32 s97, s93
  s_cselect_b32 s91, 1, 0
  s_lshl_b32 s97, s97, 10
  s_add_u32 s97, s97, s46
  s_cmp_eq_u32 s91, 1
  s_cselect_b32 s97, s97, s99
  s_add_u32 s98, s97, 88064
  buffer_load_dwordx4 v[24:27], v254, s[24:27], s97 offen sc1
  buffer_load_dwordx4 v[28:31], v254, s[24:27], s98 offen sc1
  s_waitcnt vmcnt(14)
  v_mfma_f32_32x32x16_bf16 v[176:191], v[96:99], v[32:35], v[176:191]
  v_mfma_f32_32x32x16_bf16 v[192:207], v[96:99], v[36:39], v[192:207]
  v_mfma_f32_32x32x16_bf16 v[208:223], v[100:103], v[32:35], v[208:223]
  v_mfma_f32_32x32x16_bf16 v[224:239], v[100:103], v[36:39], v[224:239]
  s_add_u32 s97, s45, 10
  s_cmp_ge_u32 s97, 22
  s_cselect_b32 s91, 22, 0
  s_sub_u32 s97, s97, s91
  s_cmp_lt_u32 s97, s93
  s_cselect_b32 s91, 1, 0
  s_lshl_b32 s97, s97, 10
  s_add_u32 s97, s97, s46
  s_cmp_eq_u32 s91, 1
  s_cselect_b32 s97, s97, s99
  s_add_u32 s98, s97, 88064
  buffer_load_dwordx4 v[32:35], v254, s[24:27], s97 offen sc1
  buffer_load_dwordx4 v[36:39], v254, s[24:27], s98 offen sc1
  s_waitcnt vmcnt(14)
  v_mfma_f32_32x32x16_bf16 v[176:191], v[104:107], v[40:43], v[176:191]
  v_mfma_f32_32x32x16_bf16 v[192:207], v[104:107], v[44:47], v[192:207]
  v_mfma_f32_32x32x16_bf16 v[208:223], v[108:111], v[40:43], v[208:223]
  v_mfma_f32_32x32x16_bf16 v[224:239], v[108:111], v[44:47], v[224:239]
  s_add_u32 s97, s45, 11
  s_cmp_ge_u32 s97, 22
  s_cselect_b32 s91, 22, 0
  s_sub_u32 s97, s97, s91
  s_cmp_lt_u32 s97, s93
  s_cselect_b32 s91, 1, 0
  s_lshl_b32 s97, s97, 10
  s_add_u32 s97, s97, s46
  s_cmp_eq_u32 s91, 1
  s_cselect_b32 s97, s97, s99
  s_add_u32 s98, s97, 88064
  buffer_load_dwordx4 v[40:43], v254, s[24:27], s97 offen sc1
  buffer_load_dwordx4 v[44:47], v254, s[24:27], s98 offen sc1
  s_waitcnt vmcnt(14)
  v_mfma_f32_32x32x16_bf16 v[176:191], v[112:115], v[48:51], v[176:191]
  v_mfma_f32_32x32x16_bf16 v[192:207], v[112:115], v[52:55], v[192:207]
  v_mfma_f32_32x32x16_bf16 v[208:223], v[116:119], v[48:51], v[208:223]
  v_mfma_f32_32x32x16_bf16 v[224:239], v[116:119], v[52:55], v[224:239]
  s_add_u32 s97, s45, 12
  s_cmp_ge_u32 s97, 22
  s_cselect_b32 s91, 22, 0
  s_sub_u32 s97, s97, s91
  s_cmp_lt_u32 s97, s93
  s_cselect_b32 s91, 1, 0
  s_lshl_b32 s97, s97, 10
  s_add_u32 s97, s97, s46
  s_cmp_eq_u32 s91, 1
  s_cselect_b32 s97, s97, s99
  s_add_u32 s98, s97, 88064
  buffer_load_dwordx4 v[48:51], v254, s[24:27], s97 offen sc1
  buffer_load_dwordx4 v[52:55], v254, s[24:27], s98 offen sc1
  s_waitcnt vmcnt(14)
  v_mfma_f32_32x32x16_bf16 v[176:191], v[120:123], v[56:59], v[176:191]
  v_mfma_f32_32x32x16_bf16 v[192:207], v[120:123], v[60:63], v[192:207]
  v_mfma_f32_32x32x16_bf16 v[208:223], v[124:127], v[56:59], v[208:223]
  v_mfma_f32_32x32x16_bf16 v[224:239], v[124:127], v[60:63], v[224:239]
  s_add_u32 s97, s45, 13
  s_cmp_ge_u32 s97, 22
  s_cselect_b32 s91, 22, 0
  s_sub_u32 s97, s97, s91
  s_cmp_lt_u32 s97, s93
  s_cselect_b32 s91, 1, 0
  s_lshl_b32 s97, s97, 10
  s_add_u32 s97, s97, s46
  s_cmp_eq_u32 s91, 1
  s_cselect_b32 s97, s97, s99
  s_add_u32 s98, s97, 88064
  buffer_load_dwordx4 v[56:59], v254, s[24:27], s97 offen sc1
  buffer_load_dwordx4 v[60:63], v254, s[24:27], s98 offen sc1
  s_waitcnt vmcnt(14)
  v_mfma_f32_32x32x16_bf16 v[176:191], v[128:131], v[64:67], v[176:191]
  v_mfma_f32_32x32x16_bf16 v[192:207], v[128:131], v[68:71], v[192:207]
  v_mfma_f32_32x32x16_bf16 v[208:223], v[132:135], v[64:67], v[208:223]
  v_mfma_f32_32x32x16_bf16 v[224:239], v[132:135], v[68:71], v[224:239]
  s_add_u32 s97, s45, 14
  s_cmp_ge_u32 s97, 22
  s_cselect_b32 s91, 22, 0
  s_sub_u32 s97, s97, s91
  s_cmp_lt_u32 s97, s93
  s_cselect_b32 s91, 1, 0
  s_lshl_b32 s97, s97, 10
  s_add_u32 s97, s97, s46
  s_cmp_eq_u32 s91, 1
  s_cselect_b32 s97, s97, s99
  s_add_u32 s98, s97, 88064
  buffer_load_dwordx4 v[64:67], v254, s[24:27], s97 offen sc1
  buffer_load_dwordx4 v[68:71], v254, s[24:27], s98 offen sc1
  s_waitcnt vmcnt(14)
  v_mfma_f32_32x32x16_bf16 v[176:191], v[136:139], v[72:75], v[176:191]
  v_mfma_f32_32x32x16_bf16 v[192:207], v[136:139], v[76:79], v[192:207]
  v_mfma_f32_32x32x16_bf16 v[208:223], v[140:143], v[72:75], v[208:223]
  v_mfma_f32_32x32x16_bf16 v[224:239], v[140:143], v[76:79], v[224:239]
  s_add_u32 s97, s45, 15
  s_cmp_ge_u32 s97, 22
  s_cselect_b32 s91, 22, 0
  s_sub_u32 s97, s97, s91
  s_cmp_lt_u32 s97, s93
  s_cselect_b32 s91, 1, 0
  s_lshl_b32 s97, s97, 10
  s_add_u32 s97, s97, s46
  s_cmp_eq_u32 s91, 1
  s_cselect_b32 s97, s97, s99
  s_add_u32 s98, s97, 88064
  buffer_load_dwordx4 v[72:75], v254, s[24:27], s97 offen sc1
  buffer_load_dwordx4 v[76:79], v254, s[24:27], s98 offen sc1
  s_waitcnt vmcnt(14)
  v_mfma_f32_32x32x16_bf16 v[176:191], v[144:147], v[16:19], v[176:191]
  v_mfma_f32_32x32x16_bf16 v[192:207], v[144:147], v[20:23], v[192:207]
  v_mfma_f32_32x32x16_bf16 v[208:223], v[148:151], v[16:19], v[208:223]
  v_mfma_f32_32x32x16_bf16 v[224:239], v[148:151], v[20:23], v[224:239]
  s_add_u32 s97, s45, 16
  s_cmp_ge_u32 s97, 22
  s_cselect_b32 s91, 22, 0
  s_sub_u32 s97, s97, s91
  s_cmp_lt_u32 s97, s93
  s_cselect_b32 s91, 1, 0
  s_lshl_b32 s97, s97, 10
  s_add_u32 s97, s97, s46
  s_cmp_eq_u32 s91, 1
  s_cselect_b32 s97, s97, s99
  s_add_u32 s98, s97, 88064
  buffer_load_dwordx4 v[16:19], v254, s[24:27], s97 offen sc1
  buffer_load_dwordx4 v[20:23], v254, s[24:27], s98 offen sc1
  s_waitcnt vmcnt(14)
  v_mfma_f32_32x32x16_bf16 v[176:191], v[152:155], v[24:27], v[176:191]
  v_mfma_f32_32x32x16_bf16 v[192:207], v[152:155], v[28:31], v[192:207]
  v_mfma_f32_32x32x16_bf16 v[208:223], v[156:159], v[24:27], v[208:223]
  v_mfma_f32_32x32x16_bf16 v[224:239], v[156:159], v[28:31], v[224:239]
  s_add_u32 s97, s45, 17
  s_cmp_ge_u32 s97, 22
  s_cselect_b32 s91, 22, 0
  s_sub_u32 s97, s97, s91
  s_cmp_lt_u32 s97, s93
  s_cselect_b32 s91, 1, 0
  s_lshl_b32 s97, s97, 10
  s_add_u32 s97, s97, s46
  s_cmp_eq_u32 s91, 1
  s_cselect_b32 s97, s97, s99
  s_add_u32 s98, s97, 88064
  buffer_load_dwordx4 v[24:27], v254, s[24:27], s97 offen sc1
  buffer_load_dwordx4 v[28:31], v254, s[24:27], s98 offen sc1
  ds_read_b64_tr_b16 v[240:241], v248 offset:0
  ds_read_b64_tr_b16 v[242:243], v248 offset:1024
  ds_read_b64_tr_b16 v[244:245], v249 offset:0
  ds_read_b64_tr_b16 v[246:247], v249 offset:1024
  s_waitcnt vmcnt(14)
  v_mfma_f32_32x32x16_bf16 v[176:191], v[160:163], v[32:35], v[176:191]
  v_mfma_f32_32x32x16_bf16 v[192:207], v[160:163], v[36:39], v[192:207]
  v_mfma_f32_32x32x16_bf16 v[208:223], v[164:167], v[32:35], v[208:223]
  v_mfma_f32_32x32x16_bf16 v[224:239], v[164:167], v[36:39], v[224:239]
  s_add_u32 s97, s45, 18
  s_cmp_ge_u32 s97, 22
  s_cselect_b32 s91, 22, 0
  s_sub_u32 s97, s97, s91
  s_cmp_lt_u32 s97, s93
  s_cselect_b32 s91, 1, 0
  s_lshl_b32 s97, s97, 10
  s_add_u32 s97, s97, s46
  s_cmp_eq_u32 s91, 1
  s_cselect_b32 s97, s97, s99
  s_add_u32 s98, s97, 88064
  buffer_load_dwordx4 v[32:35], v254, s[24:27], s97 offen sc1
  buffer_load_dwordx4 v[36:39], v254, s[24:27], s98 offen sc1
  ds_read_b64_tr_b16 v[168:169], v248 offset:2048
  ds_read_b64_tr_b16 v[170:171], v248 offset:3072
  ds_read_b64_tr_b16 v[172:173], v249 offset:2048
  ds_read_b64_tr_b16 v[174:175], v249 offset:3072
  s_waitcnt vmcnt(14)
  s_waitcnt lgkmcnt(4)
  v_mfma_f32_32x32x16_bf16 v[176:191], v[240:243], v[40:43], v[176:191]
  v_mfma_f32_32x32x16_bf16 v[192:207], v[240:243], v[44:47], v[192:207]
  v_mfma_f32_32x32x16_bf16 v[208:223], v[244:247], v[40:43], v[208:223]
  v_mfma_f32_32x32x16_bf16 v[224:239], v[244:247], v[44:47], v[224:239]
  s_add_u32 s97, s45, 19
  s_cmp_ge_u32 s97, 22
  s_cselect_b32 s91, 22, 0
  s_sub_u32 s97, s97, s91
  s_cmp_lt_u32 s97, s93
  s_cselect_b32 s91, 1, 0
  s_lshl_b32 s97, s97, 10
  s_add_u32 s97, s97, s46
  s_cmp_eq_u32 s91, 1
  s_cselect_b32 s97, s97, s99
  s_add_u32 s98, s97, 88064
  buffer_load_dwordx4 v[40:43], v254, s[24:27], s97 offen sc1
  buffer_load_dwordx4 v[44:47], v254, s[24:27], s98 offen sc1
  ds_read_b64_tr_b16 v[240:241], v248 offset:4096
  ds_read_b64_tr_b16 v[242:243], v248 offset:5120
  ds_read_b64_tr_b16 v[244:245], v249 offset:4096
  ds_read_b64_tr_b16 v[246:247], v249 offset:5120
  s_waitcnt vmcnt(14)
  s_waitcnt lgkmcnt(4)
  v_mfma_f32_32x32x16_bf16 v[176:191], v[168:171], v[48:51], v[176:191]
  v_mfma_f32_32x32x16_bf16 v[192:207], v[168:171], v[52:55], v[192:207]
  v_mfma_f32_32x32x16_bf16 v[208:223], v[172:175], v[48:51], v[208:223]
  v_mfma_f32_32x32x16_bf16 v[224:239], v[172:175], v[52:55], v[224:239]
  s_add_u32 s97, s45, 20
  s_cmp_ge_u32 s97, 22
  s_cselect_b32 s91, 22, 0
  s_sub_u32 s97, s97, s91
  s_cmp_lt_u32 s97, s93
  s_cselect_b32 s91, 1, 0
  s_lshl_b32 s97, s97, 10
  s_add_u32 s97, s97, s46
  s_cmp_eq_u32 s91, 1
  s_cselect_b32 s97, s97, s99
  s_add_u32 s98, s97, 88064
  buffer_load_dwordx4 v[48:51], v254, s[24:27], s97 offen sc1
  buffer_load_dwordx4 v[52:55], v254, s[24:27], s98 offen sc1
  ds_read_b64_tr_b16 v[168:169], v248 offset:6144
  ds_read_b64_tr_b16 v[170:171], v248 offset:7168
  ds_read_b64_tr_b16 v[172:173], v249 offset:6144
  ds_read_b64_tr_b16 v[174:175], v249 offset:7168
  s_waitcnt vmcnt(14)
  s_waitcnt lgkmcnt(4)
  v_mfma_f32_32x32x16_bf16 v[176:191], v[240:243], v[56:59], v[176:191]
  v_mfma_f32_32x32x16_bf16 v[192:207], v[240:243], v[60:63], v[192:207]
  v_mfma_f32_32x32x16_bf16 v[208:223], v[244:247], v[56:59], v[208:223]
  v_mfma_f32_32x32x16_bf16 v[224:239], v[244:247], v[60:63], v[224:239]
  s_add_u32 s97, s45, 21
  s_cmp_ge_u32 s97, 22
  s_cselect_b32 s91, 22, 0
  s_sub_u32 s97, s97, s91
  s_cmp_lt_u32 s97, s93
  s_cselect_b32 s91, 1, 0
  s_lshl_b32 s97, s97, 10
  s_add_u32 s97, s97, s46
  s_cmp_eq_u32 s91, 1
  s_cselect_b32 s97, s97, s99
  s_add_u32 s98, s97, 88064
  buffer_load_dwordx4 v[56:59], v254, s[24:27], s97 offen sc1
  buffer_load_dwordx4 v[60:63], v254, s[24:27], s98 offen sc1
  ds_read_b64_tr_b16 v[240:241], v248 offset:8192
  ds_read_b64_tr_b16 v[242:243], v248 offset:9216
  ds_read_b64_tr_b16 v[244:245], v249 offset:8192
  ds_read_b64_tr_b16 v[246:247], v249 offset:9216
  s_waitcnt vmcnt(14)
  s_waitcnt lgkmcnt(4)
  v_mfma_f32_32x32x16_bf16 v[176:191], v[168:171], v[64:67], v[176:191]
  v_mfma_f32_32x32x16_bf16 v[192:207], v[168:171], v[68:71], v[192:207]
  v_mfma_f32_32x32x16_bf16 v[208:223], v[172:175], v[64:67], v[208:223]
  v_mfma_f32_32x32x16_bf16 v[224:239], v[172:175], v[68:71], v[224:239]
  v_mov_b32 v8, 158784
  v_mov_b32 v9, 1
  ds_write_b32 v8, v9
  ds_read_b64_tr_b16 v[168:169], v250 offset:0
  ds_read_b64_tr_b16 v[170:171], v250 offset:1024
  ds_read_b64_tr_b16 v[172:173], v251 offset:0
  ds_read_b64_tr_b16 v[174:175], v251 offset:1024
  s_waitcnt vmcnt(12)
  s_waitcnt lgkmcnt(4)
  v_mfma_f32_32x32x16_bf16 v[176:191], v[240:243], v[72:75], v[176:191]
  v_mfma_f32_32x32x16_bf16 v[192:207], v[240:243], v[76:79], v[192:207]
  v_mfma_f32_32x32x16_bf16 v[208:223], v[244:247], v[72:75], v[208:223]
  v_mfma_f32_32x32x16_bf16 v[224:239], v[244:247], v[76:79], v[224:239]
  ds_read_b64_tr_b16 v[240:241], v250 offset:2048
  ds_read_b64_tr_b16 v[242:243], v250 offset:3072
  ds_read_b64_tr_b16 v[244:245], v251 offset:2048
  ds_read_b64_tr_b16 v[246:247], v251 offset:3072
  s_waitcnt vmcnt(10)
  s_waitcnt lgkmcnt(4)
  v_mfma_f32_32x32x16_bf16 v[176:191], v[168:171], v[16:19], v[176:191]
  v_mfma_f32_32x32x16_bf16 v[192:207], v[168:171], v[20:23], v[192:207]
  v_mfma_f32_32x32x16_bf16 v[208:223], v[172:175], v[16:19], v[208:223]
  v_mfma_f32_32x32x16_bf16 v[224:239], v[172:175], v[20:23], v[224:239]
  ds_read_b64_tr_b16 v[168:169], v250 offset:4096
  ds_read_b64_tr_b16 v[170:171], v250 offset:5120
  ds_read_b64_tr_b16 v[172:173], v251 offset:4096
  ds_read_b64_tr_b16 v[174:175], v251 offset:5120
  s_waitcnt vmcnt(8)
  s_waitcnt lgkmcnt(4)
  v_mfma_f32_32x32x16_bf16 v[176:191], v[240:243], v[24:27], v[176:191]
  v_mfma_f32_32x32x16_bf16 v[192:207], v[240:243], v[28:31], v[192:207]
  v_mfma_f32_32x32x16_bf16 v[208:223], v[244:247], v[24:27], v[208:223]
  v_mfma_f32_32x32x16_bf16 v[224:239], v[244:247], v[28:31], v[224:239]
  ds_read_b64_tr_b16 v[240:241], v250 offset:6144
  ds_read_b64_tr_b16 v[242:243], v250 offset:7168
  ds_read_b64_tr_b16 v[244:245], v251 offset:6144
  ds_read_b64_tr_b16 v[246:247], v251 offset:7168
  s_waitcnt vmcnt(6)
  s_waitcnt lgkmcnt(4)
  v_mfma_f32_32x32x16_bf16 v[176:191], v[168:171], v[32:35], v[176:191]
  v_mfma_f32_32x32x16_bf16 v[192:207], v[168:171], v[36:39], v[192:207]
  v_mfma_f32_32x32x16_bf16 v[208:223], v[172:175], v[32:35], v[208:223]
  v_mfma_f32_32x32x16_bf16 v[224:239], v[172:175], v[36:39], v[224:239]
  ds_read_b64_tr_b16 v[168:169], v250 offset:8192
  ds_read_b64_tr_b16 v[170:171], v250 offset:9216
  ds_read_b64_tr_b16 v[172:173], v251 offset:8192
  ds_read_b64_tr_b16 v[174:175], v251 offset:9216
  s_waitcnt vmcnt(4)
  s_waitcnt lgkmcnt(4)
  v_mfma_f32_32x32x16_bf16 v[176:191], v[240:243], v[40:43], v[176:191]
  v_mfma_f32_32x32x16_bf16 v[192:207], v[240:243], v[44:47], v[192:207]
  v_mfma_f32_32x32x16_bf16 v[208:223], v[244:247], v[40:43], v[208:223]
  v_mfma_f32_32x32x16_bf16 v[224:239], v[244:247], v[44:47], v[224:239]
  ds_read_b64_tr_b16 v[240:241], v252 offset:0
  ds_read_b64_tr_b16 v[242:243], v252 offset:1024
  ds_read_b64_tr_b16 v[244:245], v253 offset:0
  ds_read_b64_tr_b16 v[246:247], v253 offset:1024
  s_waitcnt vmcnt(2)
  s_waitcnt lgkmcnt(4)
  v_mfma_f32_32x32x16_bf16 v[176:191], v[168:171], v[48:51], v[176:191]
  v_mfma_f32_32x32x16_bf16 v[192:207], v[168:171], v[52:55], v[192:207]
  v_mfma_f32_32x32x16_bf16 v[208:223], v[172:175], v[48:51], v[208:223]
  v_mfma_f32_32x32x16_bf16 v[224:239], v[172:175], v[52:55], v[224:239]
  s_waitcnt vmcnt(0)
  s_waitcnt lgkmcnt(0)
  v_mfma_f32_32x32x16_bf16 v[176:191], v[240:243], v[56:59], v[176:191]
  v_mfma_f32_32x32x16_bf16 v[192:207], v[240:243], v[60:63], v[192:207]
  v_mfma_f32_32x32x16_bf16 v[208:223], v[244:247], v[56:59], v[208:223]
  v_mfma_f32_32x32x16_bf16 v[224:239], v[244:247], v[60:63], v[224:239]
  s_nop 7
  v_and_b32 v8, 31, v3
  v_lshrrev_b32 v9, 5, v3
  v_mul_u32_u24 v8, 272, v8
  v_lshl_add_u32 v8, v9, 4, v8
  v_add_u32 v9, s95, v8
  v_add_u32 v8, s94, v8
  ds_write_b128 v8, v[176:179] offset:0
  ds_write_b128 v8, v[180:183] offset:32
  ds_write_b128 v8, v[184:187] offset:64
  ds_write_b128 v8, v[188:191] offset:96
  ds_write_b128 v9, v[192:195] offset:0
  ds_write_b128 v9, v[196:199] offset:32
  ds_write_b128 v9, v[200:203] offset:64
  ds_write_b128 v9, v[204:207] offset:96
  ds_write_b128 v8, v[208:211] offset:128
  ds_write_b128 v8, v[212:215] offset:160
  ds_write_b128 v8, v[216:219] offset:192
  ds_write_b128 v8, v[220:223] offset:224
  ds_write_b128 v9, v[224:227] offset:128
  ds_write_b128 v9, v[228:231] offset:160
  ds_write_b128 v9, v[232:235] offset:192
  ds_write_b128 v9, v[236:239] offset:224
  s_branch L_FINAL
L_HELPER:
  s_sub_u32 s83, s76, 4
  v_lshlrev_b32 v21, 4, v3
  v_lshrrev_b32 v8, 3, v3
  v_lshrrev_b32 v9, 4, v3
  v_and_b32 v10, 7, v3
  s_lshl_b32 s88, s77, 7
  s_lshl_b32 s89, s83, 5
  s_add_u32 s88, s88, s89
  v_add_u32 v11, 0, v9
  v_xor_b32 v11, v11, v10
  v_lshlrev_b32 v11, 4, v11
  v_add_u32 v12, s88, v8
  v_add_u32 v12, 0, v12
  v_lshl_add_u32 v16, v12, 10, v11
  v_add_u32 v11, 4, v9
  v_xor_b32 v11, v11, v10
  v_lshlrev_b32 v11, 4, v11
  v_add_u32 v12, s88, v8
  v_add_u32 v12, 8, v12
  v_lshl_add_u32 v17, v12, 10, v11
  s_and_b32 s87, s83, 1
  s_lshl_b32 s89, s87, 1
  s_lshr_b32 s90, s83, 1
  s_lshl_b32 s90, s90, 5
  s_lshl_b32 s91, s81, 1
  s_movk_i32 s86, 2752
  v_add_u32 v8, 0, v3
  v_lshrrev_b32 v9, 4, v8
  v_mul_u32_u24 v9, 43, v9
  v_lshrrev_b32 v9, 7, v9
  v_mul_u32_u24 v10, 48, v9
  v_sub_u32 v10, v8, v10
  v_lshrrev_b32 v11, 4, v10
  v_bfe_u32 v12, v10, 2, 2
  v_and_b32 v10, 3, v10
  v_xor_b32 v10, s89, v10
  v_lshl_add_u32 v10, v11, 2, v10
  v_lshl_add_u32 v9, v9, 2, v12
  v_add_u32 v9, s90, v9
  v_mul_u32_u24 v9, s86, v9
  v_lshl_add_u32 v10, v10, 4, v9
  v_add_u32 v18, s91, v10
  v_add_u32 v8, 64, v3
  v_lshrrev_b32 v9, 4, v8
  v_mul_u32_u24 v9, 43, v9
  v_lshrrev_b32 v9, 7, v9
  v_mul_u32_u24 v10, 48, v9
  v_sub_u32 v10, v8, v10
  v_lshrrev_b32 v11, 4, v10
  v_bfe_u32 v12, v10, 2, 2
  v_and_b32 v10, 3, v10
  v_xor_b32 v10, s89, v10
  v_lshl_add_u32 v10, v11, 2, v10
  v_lshl_add_u32 v9, v9, 2, v12
  v_add_u32 v9, s90, v9
  v_mul_u32_u24 v9, s86, v9
  v_lshl_add_u32 v10, v10, 4, v9
  v_add_u32 v19, s91, v10
  v_add_u32 v8, 128, v3
  v_lshrrev_b32 v9, 4, v8
  v_mul_u32_u24 v9, 43, v9
  v_lshrrev_b32 v9, 7, v9
  v_mul_u32_u24 v10, 48, v9
  v_sub_u32 v10, v8, v10
  v_lshrrev_b32 v11, 4, v10
  v_bfe_u32 v12, v10, 2, 2
  v_and_b32 v10, 3, v10
  v_xor_b32 v10, s89, v10
  v_lshl_add_u32 v10, v11, 2, v10
  v_lshl_add_u32 v9, v9, 2, v12
  v_add_u32 v9, s90, v9
  v_mul_u32_u24 v9, s86, v9
  v_lshl_add_u32 v10, v10, 4, v9
  v_add_u32 v20, s91, v10
  s_lshl_b32 s95, s83, 12
  s_mul_i32 s96, s87, 12288
  s_lshr_b32 s90, s83, 1
  s_mul_i32 s90, s90, 6144
  s_add_u32 s96, s96, s90
  s_add_u32 s96, s96, 16384
  s_lshl_b32 s97, s77, 7
  s_lshl_b32 s86, s78, 3
  s_add_u32 s97, s97, s86
  s_lshl_b32 s86, s83, 1
  s_add_u32 s97, s97, s86
  v_lshrrev_b32 v8, 3, v3
  v_and_b32 v9, 7, v3
  v_lshrrev_b32 v10, 4, v3
  s_and_b32 s87, s83, 1
  s_lshl_b32 s87, s87, 2
  v_add_u32 v10, s87, v10
  v_xor_b32 v9, v9, v10
  v_lshlrev_b32 v9, 4, v9
  v_lshl_add_u32 v9, v8, 10, v9
  s_lshl_b32 s87, s80, 7
  v_add_u32 v22, s87, v9
  v_lshrrev_b32 v8, 3, v3
  v_and_b32 v9, 7, v3
  v_bfe_u32 v10, v3, 4, 1
  v_lshlrev_b32 v10, 2, v10
  v_xor_b32 v9, v9, v10
  v_lshlrev_b32 v9, 4, v9
  v_lshl_add_u32 v9, v8, 10, v9
  s_lshl_b32 s87, s80, 7
  v_add_u32 v23, s87, v9
  s_waitcnt lgkmcnt(0)
  s_mov_b32 s4, s48
  s_mov_b32 s5, s49
  s_mov_b32 s6, 2097152
  s_mov_b32 s7, 0x20000
  s_and_b32 s86, s83, 1
  s_cmp_eq_u32 s86, 0
  s_cselect_b32 s16, s62, s64
  s_cselect_b32 s17, s63, s65
  s_mov_b32 s18, 1409024
  s_mov_b32 s19, 0x20000
  s_lshl_b32 s86, s97, 10
  buffer_load_dwordx4 v[24:27], v21, s[4:7], s86 offen
  buffer_load_dwordx4 v[28:31], v21, s[4:7], s86 offen offset:1024
  s_mov_b32 s28, s70
  s_mov_b32 s29, s71
  s_mov_b32 s30, 256
  s_mov_b32 s31, 0x20000
  s_cmp_lg_u32 s2, 0
  s_cbranch_scc1 NN_22
  s_cmp_lg_u32 s76, 4
  s_cbranch_scc1 NN_22
  s_memrealtime s[86:87]
  s_waitcnt lgkmcnt(0)
  s_or_b32 s86, s86, 1
  v_mov_b32 v8, s86
  buffer_store_dword v8, off, s[28:31], 0 sc0 sc1
NN_22:
  s_barrier
  s_mov_b32 s92, 0
  s_add_u32 m0, s95, 0
  s_nop 0
  buffer_load_dwordx4 v16, s[4:7], s92 offen lds
  s_add_u32 m0, m0, 1024
  s_nop 0
  buffer_load_dwordx4 v17, s[4:7], s92 offen lds
  s_add_u32 m0, m0, 1024
  s_mov_b32 s92, 16384
  buffer_load_dwordx4 v16, s[4:7], s92 offen lds
  s_add_u32 m0, m0, 1024
  s_nop 0
  buffer_load_dwordx4 v17, s[4:7], s92 offen lds
  s_mov_b32 s93, 0
  s_add_u32 m0, s96, 0
  s_nop 0
  buffer_load_dwordx4 v18, s[16:19], s93 offen lds
  s_add_u32 m0, m0, 1024
  s_nop 0
  buffer_load_dwordx4 v19, s[16:19], s93 offen lds
  s_add_u32 m0, m0, 1024
  s_nop 0
  buffer_load_dwordx4 v20, s[16:19], s93 offen lds
  s_add_u32 m0, m0, 1024
  s_mov_b32 s93, 44032
  buffer_load_dwordx4 v18, s[16:19], s93 offen lds
  s_add_u32 m0, m0, 1024
  s_nop 0
  buffer_load_dwordx4 v19, s[16:19], s93 offen lds
  s_add_u32 m0, m0, 1024
  s_nop 0
  buffer_load_dwordx4 v20, s[16:19], s93 offen lds
  s_mov_b32 s8, s50
  s_mov_b32 s9, s51
  s_mov_b32 s10, 2097152
  s_mov_b32 s11, 0x20000
  s_mov_b32 s12, s52
  s_mov_b32 s13, s53
  s_mov_b32 s14, 2097152
  s_mov_b32 s15, 0x20000
  s_mov_b32 s24, s72
  s_mov_b32 s25, s73
  s_mov_b32 s26, 268435456
  s_mov_b32 s27, 0x20000
  s_mov_b32 s20, s66
  s_mov_b32 s21, s67
  s_mov_b32 s22, 1409024
  s_mov_b32 s23, 0x20000
  s_lshr_b32 s99, s83, 1
  s_lshl_b32 s86, s79, 16
  s_add_u32 s87, s83, 0
  s_lshl_b32 s88, s87, 13
  s_add_u32 s88, s88, s86
  s_lshl_b32 s87, s87, 10
  s_add_u32 m0, s87, 122880
  s_nop 0
  buffer_load_dwordx4 v22, s[8:11], s88 offen lds
  s_add_u32 s87, s83, 4
  s_lshl_b32 s88, s87, 13
  s_add_u32 s88, s88, s86
  s_lshl_b32 s87, s87, 10
  s_add_u32 m0, s87, 122880
  s_nop 0
  buffer_load_dwordx4 v22, s[8:11], s88 offen lds
  s_add_u32 s87, s83, 0
  s_lshl_b32 s88, s87, 13
  s_add_u32 s88, s88, s86
  s_lshl_b32 s87, s87, 10
  s_add_u32 m0, s87, 131072
  s_nop 0
  buffer_load_dwordx4 v22, s[12:15], s88 offen lds
  s_add_u32 s87, s83, 4
  s_lshl_b32 s88, s87, 13
  s_add_u32 s88, s88, s86
  s_lshl_b32 s87, s87, 10
  s_add_u32 m0, s87, 131072
  s_nop 0
  buffer_load_dwordx4 v22, s[12:15], s88 offen lds
  buffer_load_dword v33, off, s[28:31], 0 sc1
  v_lshlrev_b32 v8, 2, v3
  v_add_u32 v8, 158720, v8
  v_mov_b32 v9, 0
  s_mov_b64 s[100:101], exec
  s_mov_b64 exec, 0xffffffff
  ds_write_b32 v8, v9
  s_mov_b64 exec, s[100:101]
  s_waitcnt vmcnt(15)
  v_lshlrev_b32 v120, 16, v24
  v_and_b32 v121, 0xffff0000, v24
  v_lshlrev_b32 v122, 16, v25
  v_and_b32 v123, 0xffff0000, v25
  v_lshlrev_b32 v124, 16, v26
  v_and_b32 v125, 0xffff0000, v26
  v_lshlrev_b32 v126, 16, v27
  v_and_b32 v127, 0xffff0000, v27
  v_lshlrev_b32 v128, 16, v28
  v_and_b32 v129, 0xffff0000, v28
  v_lshlrev_b32 v130, 16, v29
  v_and_b32 v131, 0xffff0000, v29
  v_lshlrev_b32 v132, 16, v30
  v_and_b32 v133, 0xffff0000, v30
  v_lshlrev_b32 v134, 16, v31
  v_and_b32 v135, 0xffff0000, v31
  v_add_f32 v136, v120, v121
  v_add_f32 v137, v128, v129
  v_add_f32 v136, v136, v122
  v_add_f32 v137, v137, v130
  v_add_f32 v136, v136, v123
  v_add_f32 v137, v137, v131
  v_add_f32 v136, v136, v124
  v_add_f32 v137, v137, v132
  v_add_f32 v136, v136, v125
  v_add_f32 v137, v137, v133
  v_add_f32 v136, v136, v126
  v_add_f32 v137, v137, v134
  v_add_f32 v136, v136, v127
  v_add_f32 v137, v137, v135
  s_nop 1
  v_add_f32_dpp v136, v136, v136 row_shr:1 row_mask:0xf bank_mask:0xf bound_ctrl:0
  v_add_f32_dpp v137, v137, v137 row_shr:1 row_mask:0xf bank_mask:0xf bound_ctrl:0
  s_nop 0
  v_add_f32_dpp v136, v136, v136 row_shr:2 row_mask:0xf bank_mask:0xf bound_ctrl:0
  v_add_f32_dpp v137, v137, v137 row_shr:2 row_mask:0xf bank_mask:0xf bound_ctrl:0
  s_nop 0
  v_add_f32_dpp v136, v136, v136 row_shr:4 row_mask:0xf bank_mask:0xf bound_ctrl:0
  v_add_f32_dpp v137, v137, v137 row_shr:4 row_mask:0xf bank_mask:0xf bound_ctrl:0
  s_nop 0
  v_add_f32_dpp v136, v136, v136 row_shr:8 row_mask:0xf bank_mask:0xf bound_ctrl:0
  v_add_f32_dpp v137, v137, v137 row_shr:8 row_mask:0xf bank_mask:0xf bound_ctrl:0
  s_nop 0
  v_add_f32_dpp v136, v136, v136 row_bcast:15 row_mask:0xa bank_mask:0xf
  v_add_f32_dpp v137, v137, v137 row_bcast:15 row_mask:0xa bank_mask:0xf
  s_nop 0
  v_add_f32_dpp v136, v136, v136 row_bcast:31 row_mask:0xc bank_mask:0xf
  v_add_f32_dpp v137, v137, v137 row_bcast:31 row_mask:0xc bank_mask:0xf
  s_nop 1
  v_readlane_b32 s86, v136, 63
  v_readlane_b32 s87, v137, 63
  v_mov_b32 v138, 0x3b000000
  s_nop 0
  v_mul_f32 v140, s86, v138
  v_mul_f32 v141, s87, v138
  v_sub_f32 v120, v120, v140
  v_sub_f32 v128, v128, v141
  v_sub_f32 v121, v121, v140
  v_sub_f32 v129, v129, v141
  v_sub_f32 v122, v122, v140
  v_sub_f32 v130, v130, v141
  v_sub_f32 v123, v123, v140
  v_sub_f32 v131, v131, v141
  v_sub_f32 v124, v124, v140
  v_sub_f32 v132, v132, v141
  v_sub_f32 v125, v125, v140
  v_sub_f32 v133, v133, v141
  v_sub_f32 v126, v126, v140
  v_sub_f32 v134, v134, v141
  v_sub_f32 v127, v127, v140
  v_sub_f32 v135, v135, v141
  v_mul_f32 v136, v120, v120
  v_mul_f32 v137, v128, v128
  v_fma_f32 v136, v121, v121, v136
  v_fma_f32 v137, v129, v129, v137
  v_fma_f32 v136, v122, v122, v136
  v_fma_f32 v137, v130, v130, v137
  v_fma_f32 v136, v123, v123, v136
  v_fma_f32 v137, v131, v131, v137
  v_fma_f32 v136, v124, v124, v136
  v_fma_f32 v137, v132, v132, v137
  v_fma_f32 v136, v125, v125, v136
  v_fma_f32 v137, v133, v133, v137
  v_fma_f32 v136, v126, v126, v136
  v_fma_f32 v137, v134, v134, v137
  v_fma_f32 v136, v127, v127, v136
  v_fma_f32 v137, v135, v135, v137
  s_nop 1
  v_add_f32_dpp v136, v136, v136 row_shr:1 row_mask:0xf bank_mask:0xf bound_ctrl:0
  v_add_f32_dpp v137, v137, v137 row_shr:1 row_mask:0xf bank_mask:0xf bound_ctrl:0
  s_nop 0
  v_add_f32_dpp v136, v136, v136 row_shr:2 row_mask:0xf bank_mask:0xf bound_ctrl:0
  v_add_f32_dpp v137, v137, v137 row_shr:2 row_mask:0xf bank_mask:0xf bound_ctrl:0
  s_nop 0
  v_add_f32_dpp v136, v136, v136 row_shr:4 row_mask:0xf bank_mask:0xf bound_ctrl:0
  v_add_f32_dpp v137, v137, v137 row_shr:4 row_mask:0xf bank_mask:0xf bound_ctrl:0
  s_nop 0
  v_add_f32_dpp v136, v136, v136 row_shr:8 row_mask:0xf bank_mask:0xf bound_ctrl:0
  v_add_f32_dpp v137, v137, v137 row_shr:8 row_mask:0xf bank_mask:0xf bound_ctrl:0
  s_nop 0
  v_add_f32_dpp v136, v136, v136 row_bcast:15 row_mask:0xa bank_mask:0xf
  v_add_f32_dpp v137, v137, v137 row_bcast:15 row_mask:0xa bank_mask:0xf
  s_nop 0
  v_add_f32_dpp v136, v136, v136 row_bcast:31 row_mask:0xc bank_mask:0xf
  v_add_f32_dpp v137, v137, v137 row_bcast:31 row_mask:0xc bank_mask:0xf
  s_nop 1
  v_readlane_b32 s86, v136, 63
  v_readlane_b32 s87, v137, 63
  v_cmp_eq_u32 vcc, 1, v3
  s_nop 0
  v_mov_b32 v136, s86
  v_mov_b32 v137, s87
  v_cndmask_b32 v136, v136, v137, vcc
  v_cndmask_b32 v140, v140, v141, vcc
  v_mul_f32 v136, v136, v138
  v_cvt_pk_bf16_f32 v136, v136, v136
  v_lshlrev_b32 v136, 16, v136
  v_add_f32 v136, 0x3727c5ac, v136
  v_cvt_pk_bf16_f32 v136, v136, v136
  v_lshlrev_b32 v136, 16, v136
  v_sqrt_f32 v136, v136
  s_nop 0
  v_cvt_pk_bf16_f32 v110, v140, v136
  s_waitcnt vmcnt(5)
  s_waitcnt lgkmcnt(0)
  s_barrier
  s_mov_b32 s92, 256
  s_add_u32 m0, s95, 81920
  s_nop 0
  buffer_load_dwordx4 v16, s[4:7], s92 offen lds
  s_add_u32 m0, m0, 1024
  s_nop 0
  buffer_load_dwordx4 v17, s[4:7], s92 offen lds
  s_add_u32 m0, m0, 1024
  s_mov_b32 s92, 16640
  buffer_load_dwordx4 v16, s[4:7], s92 offen lds
  s_add_u32 m0, m0, 1024
  s_nop 0
  buffer_load_dwordx4 v17, s[4:7], s92 offen lds
  s_mov_b32 s93, 352256
  s_add_u32 m0, s96, 81920
  s_nop 0
  buffer_load_dwordx4 v18, s[16:19], s93 offen lds
  s_add_u32 m0, m0, 1024
  s_nop 0
  buffer_load_dwordx4 v19, s[16:19], s93 offen lds
  s_add_u32 m0, m0, 1024
  s_nop 0
  buffer_load_dwordx4 v20, s[16:19], s93 offen lds
  s_add_u32 m0, m0, 1024
  s_mov_b32 s93, 396288
  buffer_load_dwordx4 v18, s[16:19], s93 offen lds
  s_add_u32 m0, m0, 1024
  s_nop 0
  buffer_load_dwordx4 v19, s[16:19], s93 offen lds
  s_add_u32 m0, m0, 1024
  s_nop 0
  buffer_load_dwordx4 v20, s[16:19], s93 offen lds
  s_waitcnt lgkmcnt(0)
  s_barrier
  s_mov_b32 s92, 384
  s_add_u32 m0, s95, 0
  s_nop 0
  buffer_load_dwordx4 v16, s[4:7], s92 offen lds
  s_add_u32 m0, m0, 1024
  s_nop 0
  buffer_load_dwordx4 v17, s[4:7], s92 offen lds
  s_add_u32 m0, m0, 1024
  s_mov_b32 s92, 16768
  buffer_load_dwordx4 v16, s[4:7], s92 offen lds
  s_add_u32 m0, m0, 1024
  s_nop 0
  buffer_load_dwordx4 v17, s[4:7], s92 offen lds
  s_mov_b32 s93, 528384
  s_add_u32 m0, s96, 0
  s_nop 0
  buffer_load_dwordx4 v18, s[16:19], s93 offen lds
  s_add_u32 m0, m0, 1024
  s_nop 0
  buffer_load_dwordx4 v19, s[16:19], s93 offen lds
  s_add_u32 m0, m0, 1024
  s_nop 0
  buffer_load_dwordx4 v20, s[16:19], s93 offen lds
  s_add_u32 m0, m0, 1024
  s_mov_b32 s93, 572416
  buffer_load_dwordx4 v18, s[16:19], s93 offen lds
  s_add_u32 m0, m0, 1024
  s_nop 0
  buffer_load_dwordx4 v19, s[16:19], s93 offen lds
  s_add_u32 m0, m0, 1024
  s_nop 0
  buffer_load_dwordx4 v20, s[16:19], s93 offen lds
  s_waitcnt vmcnt(10)
  s_waitcnt lgkmcnt(0)
  s_barrier
  s_mov_b32 s92, 512
  s_add_u32 m0, s95, 40960
  s_nop 0
  buffer_load_dwordx4 v16, s[4:7], s92 offen lds
  s_add_u32 m0, m0, 1024
  s_nop 0
  buffer_load_dwordx4 v17, s[4:7], s92 offen lds
  s_add_u32 m0, m0, 1024
  s_mov_b32 s92, 16896
  buffer_load_dwordx4 v16, s[4:7], s92 offen lds
  s_add_u32 m0, m0, 1024
  s_nop 0
  buffer_load_dwordx4 v17, s[4:7], s92 offen lds
  s_mov_b32 s93, 704512
  s_add_u32 m0, s96, 40960
  s_nop 0
  buffer_load_dwordx4 v18, s[16:19], s93 offen lds
  s_add_u32 m0, m0, 1024
  s_nop 0
  buffer_load_dwordx4 v19, s[16:19], s93 offen lds
  s_add_u32 m0, m0, 1024
  s_nop 0
  buffer_load_dwordx4 v20, s[16:19], s93 offen lds
  s_add_u32 m0, m0, 1024
  s_mov_b32 s93, 748544
  buffer_load_dwordx4 v18, s[16:19], s93 offen lds
  s_add_u32 m0, m0, 1024
  s_nop 0
  buffer_load_dwordx4 v19, s[16:19], s93 offen lds
  s_add_u32 m0, m0, 1024
  s_nop 0
  buffer_load_dwordx4 v20, s[16:19], s93 offen lds
  s_mov_b32 s89, 0x40000
NRE_24:
  v_readfirstlane_b32 s85, v33
  s_nop 3
  s_cmp_lg_u32 s85, 0
  s_cbranch_scc1 NOK_23
  s_sub_u32 s89, s89, 1
  s_cmp_eq_u32 s89, 0
  s_cbranch_scc1 NOK_23
  s_sleep 2
  buffer_load_dword v33, off, s[28:31], 0 sc1
  s_waitcnt vmcnt(0)
  s_branch NRE_24
NOK_23:
  v_mov_b32 v8, 158752
  v_mov_b32 v111, s85
  ds_write_b32 v8, v111
  s_lshl_b32 s86, s97, 3
  s_add_u32 s86, s86, 12582912
  v_lshlrev_b32 v8, 3, v3
  s_mov_b64 s[100:101], exec
  s_mov_b64 exec, 3
  buffer_store_dwordx2 v[110:111], v8, s[24:27], s86 offen sc0 sc1
  s_mov_b64 exec, s[100:101]
  v_and_b32 v8, 3, v3
  v_bfe_u32 v9, v3, 4, 1
  v_lshl_add_u32 v8, v9, 2, v8
  v_lshlrev_b32 v8, 3, v8
  v_bfe_u32 v9, v3, 2, 2
  v_sub_u32 v8, v8, v9
  v_add_u32 v8, 7, v8
  v_lshrrev_b32 v11, 5, v3
  v_lshlrev_b32 v11, 3, v11
  s_lshl_b32 s86, s83, 1
  v_bfe_u32 v9, v8, 1, 3
  v_xor_b32 v9, s86, v9
  v_lshlrev_b32 v9, 4, v9
  v_lshl_add_u32 v9, v8, 7, v9
  v_add_u32 v9, v9, v11
  v_add_u32 v9, 122880, v9
  v_xor_b32 v10, 16, v9
  ds_read_b64_tr_b16 v[128:129], v9
  ds_read_b64_tr_b16 v[136:137], v9 offset:8192
  ds_read_b64_tr_b16 v[132:133], v10
  ds_read_b64_tr_b16 v[140:141], v10 offset:8192
  v_subrev_u32 v8, 4, v8
  v_bfe_u32 v9, v8, 1, 3
  v_xor_b32 v9, s86, v9
  v_lshlrev_b32 v9, 4, v9
  v_lshl_add_u32 v9, v8, 7, v9
  v_add_u32 v9, v9, v11
  v_add_u32 v9, 122880, v9
  v_xor_b32 v10, 16, v9
  ds_read_b64_tr_b16 v[130:131], v9
  ds_read_b64_tr_b16 v[138:139], v9 offset:8192
  ds_read_b64_tr_b16 v[134:135], v10
  ds_read_b64_tr_b16 v[142:143], v10 offset:8192
  v_and_b32 v9, 3, v3
  v_lshrrev_b32 v10, 5, v3
  v_lshl_add_u32 v9, v10, 2, v9
  v_lshlrev_b32 v9, 12, v9
  v_bfe_u32 v10, v3, 2, 3
  v_lshlrev_b32 v10, 4, v10
  v_sub_u32 v9, v9, v10
  v_add_u32 v9, 4080, v9
  s_lshl_b32 s86, s80, 6
  s_lshl_b32 s87, s83, 4
  s_add_u32 s86, s86, s87
  s_lshl_b32 s86, s86, 12
  s_lshl_b32 s87, s79, 7
  s_sub_u32 s86, s86, s87
  v_add_u32 v9, s86, v9
  v_add_u32 v10, 32768, v9
  s_mov_b32 s86, 14680064
  s_waitcnt lgkmcnt(0)
  buffer_store_dwordx4 v[128:131], v9, s[24:27], 0 offen sc0 sc1
  buffer_store_dwordx4 v[132:135], v10, s[24:27], 0 offen sc0 sc1
  buffer_store_dwordx4 v[136:139], v9, s[24:27], s86 offen sc0 sc1
  buffer_store_dwordx4 v[140:143], v10, s[24:27], s86 offen sc0 sc1
  s_waitcnt vmcnt(15)
  s_waitcnt lgkmcnt(0)
  s_barrier
  s_mov_b32 s92, 640
  s_add_u32 m0, s95, 81920
  s_nop 0
  buffer_load_dwordx4 v16, s[4:7], s92 offen lds
  s_add_u32 m0, m0, 1024
  s_nop 0
  buffer_load_dwordx4 v17, s[4:7], s92 offen lds
  s_add_u32 m0, m0, 1024
  s_mov_b32 s92, 17024
  buffer_load_dwordx4 v16, s[4:7], s92 offen lds
  s_add_u32 m0, m0, 1024
  s_nop 0
  buffer_load_dwordx4 v17, s[4:7], s92 offen lds
  s_mov_b32 s93, 880640
  s_add_u32 m0, s96, 81920
  s_nop 0
  buffer_load_dwordx4 v18, s[16:19], s93 offen lds
  s_add_u32 m0, m0, 1024
  s_nop 0
  buffer_load_dwordx4 v19, s[16:19], s93 offen lds
  s_add_u32 m0, m0, 1024
  s_nop 0
  buffer_load_dwordx4 v20, s[16:19], s93 offen lds
  s_add_u32 m0, m0, 1024
  s_mov_b32 s93, 924672
  buffer_load_dwordx4 v18, s[16:19], s93 offen lds
  s_add_u32 m0, m0, 1024
  s_nop 0
  buffer_load_dwordx4 v19, s[16:19], s93 offen lds
  s_add_u32 m0, m0, 1024
  s_nop 0
  buffer_load_dwordx4 v20, s[16:19], s93 offen lds
  s_lshl_b32 s86, s2, 1
  s_add_u32 s86, s86, s99
  s_lshl_b32 s86, s86, 12
  s_add_u32 s36, s56, s86
  s_addc_u32 s37, s57, 0
  s_mov_b32 s38, 4096
  s_mov_b32 s39, 0x20000
  s_and_b32 s87, s83, 1
  s_lshl_b32 s87, s87, 11
  s_add_u32 s88, s87, 0
  buffer_load_dwordx4 v[88:91], v21, s[36:39], s88 offen
  buffer_load_dwordx2 v[92:93], v21, s[36:39], s88 offen offset:16
  s_add_u32 s88, s87, 1024
  buffer_load_dwordx4 v[96:99], v21, s[36:39], s88 offen
  buffer_load_dwordx2 v[100:101], v21, s[36:39], s88 offen offset:16
  v_cmp_eq_u32 vcc, 1, v3
  v_mov_b32 v13, 0x10000
  s_nop 0
  v_cndmask_b32 v13, v13, 0, vcc
  buffer_load_dwordx2 v[112:113], v13, s[36:39], 0 offen
  s_waitcnt vmcnt(15)
  s_lshl_b32 s86, s80, 9
  s_lshl_b32 s87, s79, 4
  s_lshl_b32 s88, s83, 2
  s_add_u32 s86, s86, s87
  s_add_u32 s86, s86, s88
  s_add_u32 s86, s86, 13631488
  v_mov_b32 v8, s85
  s_mov_b64 s[100:101], exec
  s_mov_b64 exec, 1
  buffer_store_dword v8, off, s[24:27], s86 sc0 sc1
  s_mov_b64 exec, s[100:101]
  s_waitcnt vmcnt(21)
  s_waitcnt lgkmcnt(0)
  s_barrier
  s_mov_b32 s92, 768
  s_add_u32 m0, s95, 0
  s_nop 0
  buffer_load_dwordx4 v16, s[4:7], s92 offen lds
  s_add_u32 m0, m0, 1024
  s_nop 0
  buffer_load_dwordx4 v17, s[4:7], s92 offen lds
  s_add_u32 m0, m0, 1024
  s_mov_b32 s92, 17152
  buffer_load_dwordx4 v16, s[4:7], s92 offen lds
  s_add_u32 m0, m0, 1024
  s_nop 0
  buffer_load_dwordx4 v17, s[4:7], s92 offen lds
  s_mov_b32 s93, 1056768
  s_add_u32 m0, s96, 0
  s_nop 0
  buffer_load_dwordx4 v18, s[16:19], s93 offen lds
  s_add_u32 m0, m0, 1024
  s_nop 0
  buffer_load_dwordx4 v19, s[16:19], s93 offen lds
  s_add_u32 m0, m0, 1024
  s_nop 0
  buffer_load_dwordx4 v20, s[16:19], s93 offen lds
  s_add_u32 m0, m0, 1024
  s_mov_b32 s93, 1100800
  buffer_load_dwordx4 v18, s[16:19], s93 offen lds
  s_add_u32 m0, m0, 1024
  s_nop 0
  buffer_load_dwordx4 v19, s[16:19], s93 offen lds
  s_add_u32 m0, m0, 1024
  s_nop 0
  buffer_load_dwordx4 v20, s[16:19], s93 offen lds
  s_mul_i32 s86, s2, 5504
  s_mul_i32 s87, s83, 11
  v_add_u32 v12, s87, v3
  v_cmp_gt_u32 vcc, 11, v3
  v_lshlrev_b32 v12, 7, v12
  v_add_u32 v12, s86, v12
  v_mov_b32 v13, 2147483392
  v_cndmask_b32 v12, v13, v12, vcc
  buffer_load_dword v32, v12, s[20:23], 0 offen
  s_lshl_b32 s47, s77, 7
  s_lshl_b32 s87, s83, 5
  s_add_u32 s47, s47, s87
  s_lshl_b32 s47, s47, 3
  s_add_u32 s47, s47, 12582912
  v_and_b32 v34, 31, v3
  v_lshlrev_b32 v34, 3, v34
  buffer_load_dwordx2 v[116:117], v34, s[24:27], s47 offen sc1
  s_lshl_b32 s62, s2, 1
  s_add_u32 s62, s62, s99
  s_lshr_b32 s63, s62, 6
  s_lshl_b32 s63, s63, 9
  s_add_u32 s63, s63, 13631488
  s_lshl_b32 s86, s62, 3
  s_load_dwordx2 s[64:65], s[54:55], s86
  s_waitcnt lgkmcnt(0)
  s_and_b32 s67, s65, 0xffff0000
  s_lshl_b32 s66, s65, 16
  s_and_b32 s65, s64, 0xffff0000
  s_lshl_b32 s64, s64, 16
  s_waitcnt vmcnt(18)
  s_waitcnt lgkmcnt(0)
  s_barrier
  s_mov_b32 s92, 896
  s_add_u32 m0, s95, 40960
  s_nop 0
  buffer_load_dwordx4 v16, s[4:7], s92 offen lds
  s_add_u32 m0, m0, 1024
  s_nop 0
  buffer_load_dwordx4 v17, s[4:7], s92 offen lds
  s_add_u32 m0, m0, 1024
  s_mov_b32 s92, 17280
  buffer_load_dwordx4 v16, s[4:7], s92 offen lds
  s_add_u32 m0, m0, 1024
  s_nop 0
  buffer_load_dwordx4 v17, s[4:7], s92 offen lds
  s_mov_b32 s93, 1232896
  s_add_u32 m0, s96, 40960
  s_nop 0
  buffer_load_dwordx4 v18, s[16:19], s93 offen lds
  s_add_u32 m0, m0, 1024
  s_nop 0
  buffer_load_dwordx4 v19, s[16:19], s93 offen lds
  s_add_u32 m0, m0, 1024
  s_nop 0
  buffer_load_dwordx4 v20, s[16:19], s93 offen lds
  s_add_u32 m0, m0, 1024
  s_mov_b32 s93, 1276928
  buffer_load_dwordx4 v18, s[16:19], s93 offen lds
  s_add_u32 m0, m0, 1024
  s_nop 0
  buffer_load_dwordx4 v19, s[16:19], s93 offen lds
  s_add_u32 m0, m0, 1024
  s_nop 0
  buffer_load_dwordx4 v20, s[16:19], s93 offen lds
  s_mul_i32 s61, s83, 22
  s_cmp_eq_u32 s83, 3
  s_cselect_b32 s87, 1, 0
  s_sub_u32 s61, s61, s87
  s_cmp_lt_u32 s83, 2
  s_cselect_b32 s98, 22, 21
  s_mul_i32 s97, s80, 3
  s_mov_b32 s60, 0x20000000
  s_mul_i32 s44, s83, 10240
  s_add_u32 s45, s44, 0
  s_add_u32 s44, s44, 81920
  s_lshl_b32 s46, s83, 11
  s_add_u32 s46, s46, 68608
  s_lshl_b32 s86, s62, 12
  s_add_u32 s8, s72, s86
  s_addc_u32 s9, s73, 0
  s_mov_b32 s10, 4096
  s_mov_b32 s11, 0x20000
  s_add_u32 s86, s86, 14680064
  s_add_u32 s12, s72, s86
  s_addc_u32 s13, s73, 0
  s_mov_b32 s14, 4096
  s_mov_b32 s15, 0x20000
  v_lshlrev_b32 v13, 3, v3
  buffer_load_dwordx2 v[114:115], v13, s[24:27], s63 offen sc1
  s_waitcnt vmcnt(13)
  s_waitcnt lgkmcnt(0)
  s_barrier
  s_add_u32 s96, s97, 0
  s_cmp_ge_u32 s96, 22
  s_cselect_b32 s91, 22, 0
  s_sub_u32 s96, s96, s91
  s_cmp_lt_u32 s96, s98
  s_cselect_b32 s91, 1, 0
  s_add_u32 s96, s96, s61
  s_lshl_b32 s96, s96, 14
  s_cmp_eq_u32 s91, 1
  s_cselect_b32 s96, s96, s60
  s_add_u32 m0, s44, 0
  s_nop 0
  buffer_load_dwordx4 v23, s[20:23], s96 offen lds
  s_add_u32 m0, s44, 1024
  s_add_u32 s96, s96, 8192
  buffer_load_dwordx4 v23, s[20:23], s96 offen lds
  s_add_u32 s96, s97, 1
  s_cmp_ge_u32 s96, 22
  s_cselect_b32 s91, 22, 0
  s_sub_u32 s96, s96, s91
  s_cmp_lt_u32 s96, s98
  s_cselect_b32 s91, 1, 0
  s_add_u32 s96, s96, s61
  s_lshl_b32 s96, s96, 14
  s_cmp_eq_u32 s91, 1
  s_cselect_b32 s96, s96, s60
  s_add_u32 m0, s44, 2048
  s_nop 0
  buffer_load_dwordx4 v23, s[20:23], s96 offen lds
  s_add_u32 m0, s44, 3072
  s_add_u32 s96, s96, 8192
  buffer_load_dwordx4 v23, s[20:23], s96 offen lds
  s_add_u32 s96, s97, 2
  s_cmp_ge_u32 s96, 22
  s_cselect_b32 s91, 22, 0
  s_sub_u32 s96, s96, s91
  s_cmp_lt_u32 s96, s98
  s_cselect_b32 s91, 1, 0
  s_add_u32 s96, s96, s61
  s_lshl_b32 s96, s96, 14
  s_cmp_eq_u32 s91, 1
  s_cselect_b32 s96, s96, s60
  s_add_u32 m0, s44, 4096
  s_nop 0
  buffer_load_dwordx4 v23, s[20:23], s96 offen lds
  s_add_u32 m0, s44, 5120
  s_add_u32 s96, s96, 8192
  buffer_load_dwordx4 v23, s[20:23], s96 offen lds
  s_add_u32 s96, s97, 3
  s_cmp_ge_u32 s96, 22
  s_cselect_b32 s91, 22, 0
  s_sub_u32 s96, s96, s91
  s_cmp_lt_u32 s96, s98
  s_cselect_b32 s91, 1, 0
  s_add_u32 s96, s96, s61
  s_lshl_b32 s96, s96, 14
  s_cmp_eq_u32 s91, 1
  s_cselect_b32 s96, s96, s60
  s_add_u32 m0, s44, 6144
  s_nop 0
  buffer_load_dwordx4 v23, s[20:23], s96 offen lds
  s_add_u32 m0, s44, 7168
  s_add_u32 s96, s96, 8192
  buffer_load_dwordx4 v23, s[20:23], s96 offen lds
  s_add_u32 s96, s97, 4
  s_cmp_ge_u32 s96, 22
  s_cselect_b32 s91, 22, 0
  s_sub_u32 s96, s96, s91
  s_cmp_lt_u32 s96, s98
  s_cselect_b32 s91, 1, 0
  s_add_u32 s96, s96, s61
  s_lshl_b32 s96, s96, 14
  s_cmp_eq_u32 s91, 1
  s_cselect_b32 s96, s96, s60
  s_add_u32 m0, s44, 8192
  s_nop 0
  buffer_load_dwordx4 v23, s[20:23], s96 offen lds
  s_add_u32 m0, s44, 9216
  s_add_u32 s96, s96, 8192
  buffer_load_dwordx4 v23, s[20:23], s96 offen lds
  s_waitcnt vmcnt(21)
  s_mov_b32 s89, 0x40000
SR_25:
  v_cmp_eq_u32 vcc, s85, v117
  s_nop 1
  s_cmp_eq_u64 vcc, -1
  s_cbranch_scc1 SO_26
  s_sub_u32 s89, s89, 1
  s_cmp_eq_u32 s89, 0
  s_cbranch_scc1 SO_26
  s_sleep 2
  buffer_load_dwordx2 v[116:117], v34, s[24:27], s47 offen sc1
  s_waitcnt vmcnt(0)
  s_branch SR_25
SO_26:
  v_and_b32 v9, 0xffff0000, v116
  v_lshlrev_b32 v116, 16, v116
  v_rcp_f32 v117, v9
  s_lshl_b32 s86, s83, 8
  s_add_u32 s86, s86, 157696
  v_add_u32 v8, s86, v34
  s_nop 0
  ds_write_b64 v8, v[116:117]
  s_and_b32 s71, s83, 1
  s_mul_i32 s3, s99, 9216
  s_add_u32 s3, s3, 40960
  v_and_b32 v8, 15, v3
  v_lshrrev_b32 v9, 4, v3
  v_lshl_add_u32 v10, v9, 3, v8
  v_add_u32 v10, 1, v10
  v_and_b32 v11, 3, v10
  v_sub_u32 v10, v10, v11
  v_lshlrev_b32 v10, 1, v10
  v_mul_u32_u24 v11, 4160, v11
  v_add_u32 v10, v10, v11
  s_mul_i32 s86, s99, 16640
  s_lshl_b32 s87, s71, 8
  s_add_u32 s86, s86, s87
  s_add_u32 s86, s86, 122880
  v_add_u32 v35, s86, v10
  v_lshlrev_b32 v10, 1, v8
  v_sub_u32 v10, v9, v10
  v_add_u32 v10, 254, v10
  v_lshlrev_b32 v10, 4, v10
  s_add_u32 s86, s3, s87
  s_sub_u32 s86, s86, 3584
  v_add_u32 v29, s86, v10
  v_mov_b32 v192, 0
  v_mov_b32 v193, 0
  v_mov_b32 v194, 0
  v_mov_b32 v195, 0
  v_mov_b32 v196, 0
  v_mov_b32 v197, 0
  v_mov_b32 v198, 0
  v_mov_b32 v199, 0
  v_mov_b32 v200, 0
  v_mov_b32 v201, 0
  v_mov_b32 v202, 0
  v_mov_b32 v203, 0
  v_mov_b32 v204, 0
  v_mov_b32 v205, 0
  v_mov_b32 v206, 0
  v_mov_b32 v207, 0
  v_mov_b32 v208, 0
  v_mov_b32 v209, 0
  v_mov_b32 v210, 0
  v_mov_b32 v211, 0
  v_mov_b32 v212, 0
  v_mov_b32 v213, 0
  v_mov_b32 v214, 0
  v_mov_b32 v215, 0
  v_mov_b32 v216, 0
  v_mov_b32 v217, 0
  v_mov_b32 v218, 0
  v_mov_b32 v219, 0
  v_mov_b32 v220, 0
  v_mov_b32 v221, 0
  v_mov_b32 v222, 0
  v_mov_b32 v223, 0
  s_waitcnt vmcnt(10)
  v_cmp_eq_u32 vcc, s85, v114
  v_cmp_eq_u32 s[90:91], s85, v115
  s_nop 1
  s_and_b64 vcc, vcc, s[90:91]
  s_cmp_eq_u64 vcc, -1
  s_cselect_b32 s70, 1, 0
  s_and_b32 s88, s83, 1
  s_lshl_b32 s88, s88, 11
  s_add_u32 s88, s88, 0
  s_cmp_eq_u32 s70, 1
  s_cselect_b32 s88, s88, 0x40000000
  buffer_load_dwordx4 v[128:131], v21, s[8:11], s88 offen sc1
  buffer_load_dwordx2 v[132:133], v21, s[8:11], s88 offen offset:16 sc1
  buffer_load_dwordx4 v[160:163], v21, s[12:15], s88 offen sc1
  s_and_b32 s88, s83, 1
  s_lshl_b32 s88, s88, 11
  s_add_u32 s88, s88, 1024
  s_cmp_eq_u32 s70, 1
  s_cselect_b32 s88, s88, 0x40000000
  buffer_load_dwordx4 v[136:139], v21, s[8:11], s88 offen sc1
  buffer_load_dwordx2 v[140:141], v21, s[8:11], s88 offen offset:16 sc1
  buffer_load_dwordx4 v[164:167], v21, s[12:15], s88 offen sc1
  s_waitcnt vmcnt(17)
  s_waitcnt lgkmcnt(0)
  s_barrier
  s_add_u32 s96, s97, 5
  s_cmp_ge_u32 s96, 22
  s_cselect_b32 s91, 22, 0
  s_sub_u32 s96, s96, s91
  s_cmp_lt_u32 s96, s98
  s_cselect_b32 s91, 1, 0
  s_add_u32 s96, s96, s61
  s_lshl_b32 s96, s96, 14
  s_cmp_eq_u32 s91, 1
  s_cselect_b32 s96, s96, s60
  s_add_u32 m0, s45, 0
  s_nop 0
  buffer_load_dwordx4 v23, s[20:23], s96 offen lds
  s_add_u32 m0, s45, 1024
  s_add_u32 s96, s96, 8192
  buffer_load_dwordx4 v23, s[20:23], s96 offen lds
  s_add_u32 s96, s97, 6
  s_cmp_ge_u32 s96, 22
  s_cselect_b32 s91, 22, 0
  s_sub_u32 s96, s96, s91
  s_cmp_lt_u32 s96, s98
  s_cselect_b32 s91, 1, 0
  s_add_u32 s96, s96, s61
  s_lshl_b32 s96, s96, 14
  s_cmp_eq_u32 s91, 1
  s_cselect_b32 s96, s96, s60
  s_add_u32 m0, s45, 2048
  s_nop 0
  buffer_load_dwordx4 v23, s[20:23], s96 offen lds
  s_add_u32 m0, s45, 3072
  s_add_u32 s96, s96, 8192
  buffer_load_dwordx4 v23, s[20:23], s96 offen lds
  s_add_u32 s96, s97, 7
  s_cmp_ge_u32 s96, 22
  s_cselect_b32 s91, 22, 0
  s_sub_u32 s96, s96, s91
  s_cmp_lt_u32 s96, s98
  s_cselect_b32 s91, 1, 0
  s_add_u32 s96, s96, s61
  s_lshl_b32 s96, s96, 14
  s_cmp_eq_u32 s91, 1
  s_cselect_b32 s96, s96, s60
  s_add_u32 m0, s45, 4096
  s_nop 0
  buffer_load_dwordx4 v23, s[20:23], s96 offen lds
  s_add_u32 m0, s45, 5120
  s_add_u32 s96, s96, 8192
  buffer_load_dwordx4 v23, s[20:23], s96 offen lds
  s_add_u32 s96, s97, 8
  s_cmp_ge_u32 s96, 22
  s_cselect_b32 s91, 22, 0
  s_sub_u32 s96, s96, s91
  s_cmp_lt_u32 s96, s98
  s_cselect_b32 s91, 1, 0
  s_add_u32 s96, s96, s61
  s_lshl_b32 s96, s96, 14
  s_cmp_eq_u32 s91, 1
  s_cselect_b32 s96, s96, s60
  s_add_u32 m0, s45, 6144
  s_nop 0
  buffer_load_dwordx4 v23, s[20:23], s96 offen lds
  s_add_u32 m0, s45, 7168
  s_add_u32 s96, s96, 8192
  buffer_load_dwordx4 v23, s[20:23], s96 offen lds
  s_add_u32 s96, s97, 9
  s_cmp_ge_u32 s96, 22
  s_cselect_b32 s91, 22, 0
  s_sub_u32 s96, s96, s91
  s_cmp_lt_u32 s96, s98
  s_cselect_b32 s91, 1, 0
  s_add_u32 s96, s96, s61
  s_lshl_b32 s96, s96, 14
  s_cmp_eq_u32 s91, 1
  s_cselect_b32 s96, s96, s60
  s_add_u32 m0, s45, 8192
  s_nop 0
  buffer_load_dwordx4 v23, s[20:23], s96 offen lds
  s_add_u32 m0, s45, 9216
  s_add_u32 s96, s96, 8192
  buffer_load_dwordx4 v23, s[20:23], s96 offen lds
  s_cmp_eq_u32 s70, 1
  s_cbranch_scc0 K7_27
  s_waitcnt vmcnt(10)
  v_lshlrev_b32 v36, 16, v128
  v_and_b32 v37, 0xffff0000, v128
  v_lshlrev_b32 v38, 16, v129
  v_and_b32 v39, 0xffff0000, v129
  v_lshlrev_b32 v40, 16, v130
  v_and_b32 v41, 0xffff0000, v130
  v_lshlrev_b32 v42, 16, v131
  v_and_b32 v43, 0xffff0000, v131
  v_lshlrev_b32 v44, 16, v132
  v_and_b32 v45, 0xffff0000, v132
  v_lshlrev_b32 v46, 16, v133
  v_lshlrev_b32 v47, 16, v160
  v_and_b32 v48, 0xffff0000, v160
  v_lshlrev_b32 v49, 16, v161
  v_and_b32 v50, 0xffff0000, v161
  v_lshlrev_b32 v51, 16, v162
  v_and_b32 v52, 0xffff0000, v162
  v_lshlrev_b32 v53, 16, v163
  v_and_b32 v54, 0xffff0000, v163
  v_mul_f32 v56, s67, v39
  v_mul_f32 v57, s67, v40
  v_mul_f32 v58, s67, v41
  v_mul_f32 v59, s67, v42
  v_mul_f32 v60, s67, v43
  v_mul_f32 v61, s67, v44
  v_mul_f32 v62, s67, v45
  v_mul_f32 v63, s67, v46
  v_fma_f32 v56, v38, s66, v56
  v_fma_f32 v57, v39, s66, v57
  v_fma_f32 v58, v40, s66, v58
  v_fma_f32 v59, v41, s66, v59
  v_fma_f32 v60, v42, s66, v60
  v_fma_f32 v61, v43, s66, v61
  v_fma_f32 v62, v44, s66, v62
  v_fma_f32 v63, v45, s66, v63
  v_fma_f32 v56, v37, s65, v56
  v_fma_f32 v57, v38, s65, v57
  v_fma_f32 v58, v39, s65, v58
  v_fma_f32 v59, v40, s65, v59
  v_fma_f32 v60, v41, s65, v60
  v_fma_f32 v61, v42, s65, v61
  v_fma_f32 v62, v43, s65, v62
  v_fma_f32 v63, v44, s65, v63
  v_fma_f32 v56, v36, s64, v56
  v_fma_f32 v57, v37, s64, v57
  v_fma_f32 v58, v38, s64, v58
  v_fma_f32 v59, v39, s64, v59
  v_fma_f32 v60, v40, s64, v60
  v_fma_f32 v61, v41, s64, v61
  v_fma_f32 v62, v42, s64, v62
  v_fma_f32 v63, v43, s64, v63
  v_mul_f32 v56, v56, v47
  v_mul_f32 v57, v57, v48
  v_mul_f32 v58, v58, v49
  v_mul_f32 v59, v59, v50
  v_mul_f32 v60, v60, v51
  v_mul_f32 v61, v61, v52
  v_mul_f32 v62, v62, v53
  v_mul_f32 v63, v63, v54
  v_cvt_pk_bf16_f32 v128, v56, v57
  v_cvt_pk_bf16_f32 v129, v58, v59
  v_cvt_pk_bf16_f32 v130, v60, v61
  v_cvt_pk_bf16_f32 v131, v62, v63
  v_lshlrev_b32 v36, 16, v136
  v_and_b32 v37, 0xffff0000, v136
  v_lshlrev_b32 v38, 16, v137
  v_and_b32 v39, 0xffff0000, v137
  v_lshlrev_b32 v40, 16, v138
  v_and_b32 v41, 0xffff0000, v138
  v_lshlrev_b32 v42, 16, v139
  v_and_b32 v43, 0xffff0000, v139
  v_lshlrev_b32 v44, 16, v140
  v_and_b32 v45, 0xffff0000, v140
  v_lshlrev_b32 v46, 16, v141
  v_lshlrev_b32 v47, 16, v164
  v_and_b32 v48, 0xffff0000, v164
  v_lshlrev_b32 v49, 16, v165
  v_and_b32 v50, 0xffff0000, v165
  v_lshlrev_b32 v51, 16, v166
  v_and_b32 v52, 0xffff0000, v166
  v_lshlrev_b32 v53, 16, v167
  v_and_b32 v54, 0xffff0000, v167
  v_mul_f32 v56, s67, v39
  v_mul_f32 v57, s67, v40
  v_mul_f32 v58, s67, v41
  v_mul_f32 v59, s67, v42
  v_mul_f32 v60, s67, v43
  v_mul_f32 v61, s67, v44
  v_mul_f32 v62, s67, v45
  v_mul_f32 v63, s67, v46
  v_fma_f32 v56, v38, s66, v56
  v_fma_f32 v57, v39, s66, v57
  v_fma_f32 v58, v40, s66, v58
  v_fma_f32 v59, v41, s66, v59
  v_fma_f32 v60, v42, s66, v60
  v_fma_f32 v61, v43, s66, v61
  v_fma_f32 v62, v44, s66, v62
  v_fma_f32 v63, v45, s66, v63
  v_fma_f32 v56, v37, s65, v56
  v_fma_f32 v57, v38, s65, v57
  v_fma_f32 v58, v39, s65, v58
  v_fma_f32 v59, v40, s65, v59
  v_fma_f32 v60, v41, s65, v60
  v_fma_f32 v61, v42, s65, v61
  v_fma_f32 v62, v43, s65, v62
  v_fma_f32 v63, v44, s65, v63
  v_fma_f32 v56, v36, s64, v56
  v_fma_f32 v57, v37, s64, v57
  v_fma_f32 v58, v38, s64, v58
  v_fma_f32 v59, v39, s64, v59
  v_fma_f32 v60, v40, s64, v60
  v_fma_f32 v61, v41, s64, v61
  v_fma_f32 v62, v42, s64, v62
  v_fma_f32 v63, v43, s64, v63
  v_mul_f32 v56, v56, v47
  v_mul_f32 v57, v57, v48
  v_mul_f32 v58, v58, v49
  v_mul_f32 v59, v59, v50
  v_mul_f32 v60, v60, v51
  v_mul_f32 v61, v61, v52
  v_mul_f32 v62, v62, v53
  v_mul_f32 v63, v63, v54
  v_cvt_pk_bf16_f32 v136, v56, v57
  v_cvt_pk_bf16_f32 v137, v58, v59
  v_cvt_pk_bf16_f32 v138, v60, v61
  v_cvt_pk_bf16_f32 v139, v62, v63
K7_27:
  s_waitcnt lgkmcnt(0)
  s_barrier
  s_add_u32 s96, s97, 10
  s_cmp_ge_u32 s96, 22
  s_cselect_b32 s91, 22, 0
  s_sub_u32 s96, s96, s91
  s_cmp_lt_u32 s96, s98
  s_cselect_b32 s91, 1, 0
  s_add_u32 s96, s96, s61
  s_lshl_b32 s96, s96, 14
  s_cmp_eq_u32 s91, 1
  s_cselect_b32 s96, s96, s60
  s_add_u32 m0, s46, 0
  s_nop 0
  buffer_load_dwordx4 v23, s[20:23], s96 offen lds
  s_add_u32 m0, s46, 1024
  s_add_u32 s96, s96, 8192
  buffer_load_dwordx4 v23, s[20:23], s96 offen lds
  s_mov_b32 s40, s58
  s_mov_b32 s41, s59
  s_mov_b32 s42, 1024
  s_mov_b32 s43, 0x20000
  s_lshl_b32 s86, s62, 1
  buffer_load_ushort v32, off, s[40:43], s86
  s_and_b32 s71, s83, 1
  s_mul_i32 s86, s99, 16640
  s_add_u32 s86, s86, 122880
  s_lshl_b32 s87, s71, 11
  s_add_u32 s87, s87, s86
  v_add_u32 v27, s86, v21
  v_add_u32 v28, s87, v21
  v_alignbit_b32 v116, v89, v88, 16
  v_mov_b32 v120, v89
  v_alignbit_b32 v124, v90, v89, 16
  v_alignbit_b32 v117, v90, v89, 16
  v_mov_b32 v121, v90
  v_alignbit_b32 v125, v91, v90, 16
  v_alignbit_b32 v118, v91, v90, 16
  v_mov_b32 v122, v91
  v_alignbit_b32 v126, v92, v91, 16
  v_alignbit_b32 v119, v92, v91, 16
  v_mov_b32 v123, v92
  v_alignbit_b32 v127, v93, v92, 16
  ds_write_b128 v28, v[88:91] offset:32
  ds_write_b128 v28, v[116:119] offset:4192
  ds_write_b128 v28, v[120:123] offset:8352
  ds_write_b128 v28, v[124:127] offset:12512
  s_nop 1
  v_alignbit_b32 v116, v97, v96, 16
  v_mov_b32 v120, v97
  v_alignbit_b32 v124, v98, v97, 16
  v_alignbit_b32 v117, v98, v97, 16
  v_mov_b32 v121, v98
  v_alignbit_b32 v125, v99, v98, 16
  v_alignbit_b32 v118, v99, v98, 16
  v_mov_b32 v122, v99
  v_alignbit_b32 v126, v100, v99, 16
  v_alignbit_b32 v119, v100, v99, 16
  v_mov_b32 v123, v100
  v_alignbit_b32 v127, v101, v100, 16
  ds_write_b128 v28, v[96:99] offset:1056
  ds_write_b128 v28, v[116:119] offset:5216
  ds_write_b128 v28, v[120:123] offset:9376
  ds_write_b128 v28, v[124:127] offset:13536
  s_nop 1
  s_cmp_lg_u32 s71, 0
  s_cbranch_scc1 PB_28
  s_mov_b64 s[100:101], exec
  s_mov_b64 exec, 3
  v_mov_b32 v88, 0
  v_mov_b32 v89, 0
  v_mov_b32 v90, 0
  v_mov_b32 v91, 0
  v_mov_b32 v92, v112
  v_mov_b32 v93, v113
  v_alignbit_b32 v116, v89, v88, 16
  v_mov_b32 v120, v89
  v_alignbit_b32 v124, v90, v89, 16
  v_alignbit_b32 v117, v90, v89, 16
  v_mov_b32 v121, v90
  v_alignbit_b32 v125, v91, v90, 16
  v_alignbit_b32 v118, v91, v90, 16
  v_mov_b32 v122, v91
  v_alignbit_b32 v126, v92, v91, 16
  v_alignbit_b32 v119, v92, v91, 16
  v_mov_b32 v123, v92
  v_alignbit_b32 v127, v93, v92, 16
  ds_write_b128 v27, v[88:91] offset:0
  ds_write_b128 v27, v[116:119] offset:4160
  ds_write_b128 v27, v[120:123] offset:8320
  ds_write_b128 v27, v[124:127] offset:12480
  s_nop 1
  s_mov_b64 exec, s[100:101]
PB_28:
  s_waitcnt lgkmcnt(0)
  s_lshl_b32 s86, s83, 2
  s_add_u32 s86, s86, 158720
  v_mov_b32 v30, s86
  v_mov_b32 v31, 1
  s_waitcnt vmcnt(1)
  ds_write_b32 v30, v31 offset:16
  s_cmp_eq_u32 s70, 1
  s_cbranch_scc1 KO2_29
  s_mov_b32 s89, 0x40000
POLL_31:
  v_lshlrev_b32 v13, 3, v3
  buffer_load_dwordx2 v[114:115], v13, s[24:27], s63 offen sc1
  s_waitcnt vmcnt(0)
  v_cmp_eq_u32 vcc, s85, v114
  v_cmp_eq_u32 s[90:91], s85, v115
  s_nop 1
  s_and_b64 vcc, vcc, s[90:91]
  s_cmp_eq_u64 vcc, -1
  s_cbranch_scc1 POLLD_32
  s_sub_u32 s89, s89, 1
  s_cmp_eq_u32 s89, 0
  s_cbranch_scc1 POLLD_32
  s_sleep 4
  s_branch POLL_31
POLLD_32:
  s_and_b32 s88, s83, 1
  s_lshl_b32 s88, s88, 11
  s_add_u32 s88, s88, 0
  buffer_load_dwordx4 v[128:131], v21, s[8:11], s88 offen sc1
  buffer_load_dwordx2 v[132:133], v21, s[8:11], s88 offen offset:16 sc1
  buffer_load_dwordx4 v[160:163], v21, s[12:15], s88 offen sc1
  s_and_b32 s88, s83, 1
  s_lshl_b32 s88, s88, 11
  s_add_u32 s88, s88, 1024
  buffer_load_dwordx4 v[136:139], v21, s[8:11], s88 offen sc1
  buffer_load_dwordx2 v[140:141], v21, s[8:11], s88 offen offset:16 sc1
  buffer_load_dwordx4 v[164:167], v21, s[12:15], s88 offen sc1
  s_waitcnt vmcnt(0)
  v_lshlrev_b32 v36, 16, v128
  v_and_b32 v37, 0xffff0000, v128
  v_lshlrev_b32 v38, 16, v129
  v_and_b32 v39, 0xffff0000, v129
  v_lshlrev_b32 v40, 16, v130
  v_and_b32 v41, 0xffff0000, v130
  v_lshlrev_b32 v42, 16, v131
  v_and_b32 v43, 0xffff0000, v131
  v_lshlrev_b32 v44, 16, v132
  v_and_b32 v45, 0xffff0000, v132
  v_lshlrev_b32 v46, 16, v133
  v_lshlrev_b32 v47, 16, v160
  v_and_b32 v48, 0xffff0000, v160
  v_lshlrev_b32 v49, 16, v161
  v_and_b32 v50, 0xffff0000, v161
  v_lshlrev_b32 v51, 16, v162
  v_and_b32 v52, 0xffff0000, v162
  v_lshlrev_b32 v53, 16, v163
  v_and_b32 v54, 0xffff0000, v163
  v_mul_f32 v56, s67, v39
  v_mul_f32 v57, s67, v40
  v_mul_f32 v58, s67, v41
  v_mul_f32 v59, s67, v42
  v_mul_f32 v60, s67, v43
  v_mul_f32 v61, s67, v44
  v_mul_f32 v62, s67, v45
  v_mul_f32 v63, s67, v46
  v_fma_f32 v56, v38, s66, v56
  v_fma_f32 v57, v39, s66, v57
  v_fma_f32 v58, v40, s66, v58
  v_fma_f32 v59, v41, s66, v59
  v_fma_f32 v60, v42, s66, v60
  v_fma_f32 v61, v43, s66, v61
  v_fma_f32 v62, v44, s66, v62
  v_fma_f32 v63, v45, s66, v63
  v_fma_f32 v56, v37, s65, v56
  v_fma_f32 v57, v38, s65, v57
  v_fma_f32 v58, v39, s65, v58
  v_fma_f32 v59, v40, s65, v59
  v_fma_f32 v60, v41, s65, v60
  v_fma_f32 v61, v42, s65, v61
  v_fma_f32 v62, v43, s65, v62
  v_fma_f32 v63, v44, s65, v63
  v_fma_f32 v56, v36, s64, v56
  v_fma_f32 v57, v37, s64, v57
  v_fma_f32 v58, v38, s64, v58
  v_fma_f32 v59, v39, s64, v59
  v_fma_f32 v60, v40, s64, v60
  v_fma_f32 v61, v41, s64, v61
  v_fma_f32 v62, v42, s64, v62
  v_fma_f32 v63, v43, s64, v63
  v_mul_f32 v56, v56, v47
  v_mul_f32 v57, v57, v48
  v_mul_f32 v58, v58, v49
  v_mul_f32 v59, v59, v50
  v_mul_f32 v60, v60, v51
  v_mul_f32 v61, v61, v52
  v_mul_f32 v62, v62, v53
  v_mul_f32 v63, v63, v54
  v_cvt_pk_bf16_f32 v128, v56, v57
  v_cvt_pk_bf16_f32 v129, v58, v59
  v_cvt_pk_bf16_f32 v130, v60, v61
  v_cvt_pk_bf16_f32 v131, v62, v63
  v_lshlrev_b32 v36, 16, v136
  v_and_b32 v37, 0xffff0000, v136
  v_lshlrev_b32 v38, 16, v137
  v_and_b32 v39, 0xffff0000, v137
  v_lshlrev_b32 v40, 16, v138
  v_and_b32 v41, 0xffff0000, v138
  v_lshlrev_b32 v42, 16, v139
  v_and_b32 v43, 0xffff0000, v139
  v_lshlrev_b32 v44, 16, v140
  v_and_b32 v45, 0xffff0000, v140
  v_lshlrev_b32 v46, 16, v141
  v_lshlrev_b32 v47, 16, v164
  v_and_b32 v48, 0xffff0000, v164
  v_lshlrev_b32 v49, 16, v165
  v_and_b32 v50, 0xffff0000, v165
  v_lshlrev_b32 v51, 16, v166
  v_and_b32 v52, 0xffff0000, v166
  v_lshlrev_b32 v53, 16, v167
  v_and_b32 v54, 0xffff0000, v167
  v_mul_f32 v56, s67, v39
  v_mul_f32 v57, s67, v40
  v_mul_f32 v58, s67, v41
  v_mul_f32 v59, s67, v42
  v_mul_f32 v60, s67, v43
  v_mul_f32 v61, s67, v44
  v_mul_f32 v62, s67, v45
  v_mul_f32 v63, s67, v46
  v_fma_f32 v56, v38, s66, v56
  v_fma_f32 v57, v39, s66, v57
  v_fma_f32 v58, v40, s66, v58
  v_fma_f32 v59, v41, s66, v59
  v_fma_f32 v60, v42, s66, v60
  v_fma_f32 v61, v43, s66, v61
  v_fma_f32 v62, v44, s66, v62
  v_fma_f32 v63, v45, s66, v63
  v_fma_f32 v56, v37, s65, v56
  v_fma_f32 v57, v38, s65, v57
  v_fma_f32 v58, v39, s65, v58
  v_fma_f32 v59, v40, s65, v59
  v_fma_f32 v60, v41, s65, v60
  v_fma_f32 v61, v42, s65, v61
  v_fma_f32 v62, v43, s65, v62
  v_fma_f32 v63, v44, s65, v63
  v_fma_f32 v56, v36, s64, v56
  v_fma_f32 v57, v37, s64, v57
  v_fma_f32 v58, v38, s64, v58
  v_fma_f32 v59, v39, s64, v59
  v_fma_f32 v60, v40, s64, v60
  v_fma_f32 v61, v41, s64, v61
  v_fma_f32 v62, v42, s64, v62
  v_fma_f32 v63, v43, s64, v63
  v_mul_f32 v56, v56, v47
  v_mul_f32 v57, v57, v48
  v_mul_f32 v58, v58, v49
  v_mul_f32 v59, v59, v50
  v_mul_f32 v60, v60, v51
  v_mul_f32 v61, v61, v52
  v_mul_f32 v62, v62, v53
  v_mul_f32 v63, v63, v54
  v_cvt_pk_bf16_f32 v136, v56, v57
  v_cvt_pk_bf16_f32 v137, v58, v59
  v_cvt_pk_bf16_f32 v138, v60, v61
  v_cvt_pk_bf16_f32 v139, v62, v63
KO2_29:
  s_waitcnt vmcnt(0)
  s_lshl_b32 s86, s71, 11
  s_add_u32 s86, s86, s3
  v_add_u32 v26, s86, v21
  ds_write_b128 v26, v[128:131] offset:0
  ds_write_b128 v26, v[136:139] offset:1024
  v_mov_b32 v52, 0
  v_mov_b32 v53, 0
  v_mov_b32 v54, 0
  v_mov_b32 v55, 0
  v_and_b32 v8, 31, v3
  v_lshlrev_b32 v8, 4, v8
  v_add_u32 v8, s3, v8
  ds_write_b128 v8, v[52:55] offset:4096
  s_waitcnt lgkmcnt(0)
  ds_write_b32 v30, v31 offset:96
  v_lshlrev_b32 v32, 16, v32
  s_lshl_b32 s86, s83, 2
  s_xor_b32 s86, s86, 4
  s_add_u32 s86, s86, 158816
  v_mov_b32 v8, s86
  s_mov_b32 s89, 0x200000
LS_33:
  ds_read_b32 v9, v8
  s_waitcnt lgkmcnt(0)
  v_readfirstlane_b32 s88, v9
  s_nop 3
  s_cmp_eq_u32 s88, 1
  s_cbranch_scc1 LSD_34
  s_sub_u32 s89, s89, 1
  s_cmp_eq_u32 s89, 0
  s_cbranch_scc1 LSD_34
  s_sleep 1
  s_branch LS_33
LSD_34:
  s_waitcnt lgkmcnt(0)
  s_lshl_b32 s86, s83, 2
  s_add_u32 s86, s86, 158768
  v_mov_b32 v8, s86
  s_mov_b32 s89, 0x200000
LS_35:
  ds_read_b32 v9, v8
  s_waitcnt lgkmcnt(0)
  v_readfirstlane_b32 s88, v9
  s_nop 3
  s_cmp_eq_u32 s88, 1
  s_cbranch_scc1 LSD_36
  s_sub_u32 s89, s89, 1
  s_cmp_eq_u32 s89, 0
  s_cbranch_scc1 LSD_36
  s_sleep 1
  s_branch LS_35
LSD_36:
  v_and_b32 v8, 15, v3
  v_lshrrev_b32 v9, 4, v3
  v_lshlrev_b32 v10, 2, v8
  v_add_u32 v10, v10, v9
  v_lshlrev_b32 v10, 3, v10
  s_lshl_b32 s87, s71, 11
  s_sub_u32 s86, s3, s87
  s_add_u32 s86, s86, 2552
  v_sub_u32 v11, s86, v10
  ds_read_b64 v[224:225], v11 offset:1536
  ds_read_b64 v[226:227], v11 offset:1024
  ds_read_b64 v[228:229], v11 offset:512
  ds_read_b64 v[230:231], v11 offset:0
  ds_read_b64 v[64:65], v35 offset:0
  ds_read_b64 v[66:67], v35 offset:8
  ds_read_b128 v[96:99], v29 offset:3584
  ds_read_b64 v[68:69], v35 offset:512
  ds_read_b64 v[70:71], v35 offset:520
  ds_read_b128 v[100:103], v29 offset:3072
  ds_read_b64 v[72:73], v35 offset:1024
  ds_read_b64 v[74:75], v35 offset:1032
  ds_read_b128 v[104:107], v29 offset:2560
  ds_read_b64 v[76:77], v35 offset:1536
  ds_read_b64 v[78:79], v35 offset:1544
  ds_read_b128 v[108:111], v29 offset:2048
  ds_read_b64 v[80:81], v35 offset:2048
  ds_read_b64 v[82:83], v35 offset:2056
  ds_read_b128 v[112:115], v29 offset:1536
  ds_read_b64 v[84:85], v35 offset:2560
  ds_read_b64 v[86:87], v35 offset:2568
  ds_read_b128 v[116:119], v29 offset:1024
  ds_read_b64 v[88:89], v35 offset:3072
  ds_read_b64 v[90:91], v35 offset:3080
  ds_read_b128 v[120:123], v29 offset:512
  ds_read_b64 v[92:93], v35 offset:3584
  ds_read_b64 v[94:95], v35 offset:3592
  ds_read_b128 v[124:127], v29 offset:0
  s_waitcnt lgkmcnt(0)
  v_mfma_f32_16x16x32_bf16 v[192:195], v[64:67], v[96:99], v[192:195]
  ds_read_b64 v[128:129], v35 offset:64
  v_mfma_f32_16x16x32_bf16 v[196:199], v[64:67], v[100:103], v[196:199]
  ds_read_b64 v[130:131], v35 offset:72
  v_mfma_f32_16x16x32_bf16 v[196:199], v[68:71], v[96:99], v[196:199]
  ds_read_b128 v[160:163], v29 offset:3648
  v_mfma_f32_16x16x32_bf16 v[200:203], v[64:67], v[104:107], v[200:203]
  ds_read_b64 v[132:133], v35 offset:576
  v_mfma_f32_16x16x32_bf16 v[200:203], v[68:71], v[100:103], v[200:203]
  ds_read_b64 v[134:135], v35 offset:584
  v_mfma_f32_16x16x32_bf16 v[200:203], v[72:75], v[96:99], v[200:203]
  ds_read_b128 v[164:167], v29 offset:3136
  v_mfma_f32_16x16x32_bf16 v[204:207], v[64:67], v[108:111], v[204:207]
  ds_read_b64 v[136:137], v35 offset:1088
  v_mfma_f32_16x16x32_bf16 v[204:207], v[68:71], v[104:107], v[204:207]
  ds_read_b64 v[138:139], v35 offset:1096
  v_mfma_f32_16x16x32_bf16 v[204:207], v[72:75], v[100:103], v[204:207]
  ds_read_b128 v[168:171], v29 offset:2624
  v_mfma_f32_16x16x32_bf16 v[204:207], v[76:79], v[96:99], v[204:207]
  ds_read_b64 v[140:141], v35 offset:1600
  v_mfma_f32_16x16x32_bf16 v[208:211], v[64:67], v[112:115], v[208:211]
  ds_read_b64 v[142:143], v35 offset:1608
  v_mfma_f32_16x16x32_bf16 v[208:211], v[68:71], v[108:111], v[208:211]
  ds_read_b128 v[172:175], v29 offset:2112
  v_mfma_f32_16x16x32_bf16 v[208:211], v[72:75], v[104:107], v[208:211]
  ds_read_b64 v[144:145], v35 offset:2112
  v_mfma_f32_16x16x32_bf16 v[208:211], v[76:79], v[100:103], v[208:211]
  ds_read_b64 v[146:147], v35 offset:2120
  v_mfma_f32_16x16x32_bf16 v[208:211], v[80:83], v[96:99], v[208:211]
  ds_read_b128 v[176:179], v29 offset:1600
  v_mfma_f32_16x16x32_bf16 v[212:215], v[64:67], v[116:119], v[212:215]
  ds_read_b64 v[148:149], v35 offset:2624
  v_mfma_f32_16x16x32_bf16 v[212:215], v[68:71], v[112:115], v[212:215]
  ds_read_b64 v[150:151], v35 offset:2632
  v_mfma_f32_16x16x32_bf16 v[212:215], v[72:75], v[108:111], v[212:215]
  ds_read_b128 v[180:183], v29 offset:1088
  v_mfma_f32_16x16x32_bf16 v[212:215], v[76:79], v[104:107], v[212:215]
  ds_read_b64 v[152:153], v35 offset:3136
  v_mfma_f32_16x16x32_bf16 v[212:215], v[80:83], v[100:103], v[212:215]
  ds_read_b64 v[154:155], v35 offset:3144
  v_mfma_f32_16x16x32_bf16 v[212:215], v[84:87], v[96:99], v[212:215]
  ds_read_b128 v[184:187], v29 offset:576
  v_mfma_f32_16x16x32_bf16 v[216:219], v[64:67], v[120:123], v[216:219]
  ds_read_b64 v[156:157], v35 offset:3648
  v_mfma_f32_16x16x32_bf16 v[216:219], v[68:71], v[116:119], v[216:219]
  ds_read_b64 v[158:159], v35 offset:3656
  v_mfma_f32_16x16x32_bf16 v[216:219], v[72:75], v[112:115], v[216:219]
  ds_read_b128 v[188:191], v29 offset:64
  v_mfma_f32_16x16x32_bf16 v[216:219], v[76:79], v[108:111], v[216:219]
  v_mfma_f32_16x16x32_bf16 v[216:219], v[80:83], v[104:107], v[216:219]
  v_mfma_f32_16x16x32_bf16 v[216:219], v[84:87], v[100:103], v[216:219]
  v_mfma_f32_16x16x32_bf16 v[216:219], v[88:91], v[96:99], v[216:219]
  v_mfma_f32_16x16x32_bf16 v[220:223], v[64:67], v[124:127], v[220:223]
  v_mfma_f32_16x16x32_bf16 v[220:223], v[68:71], v[120:123], v[220:223]
  v_mfma_f32_16x16x32_bf16 v[220:223], v[72:75], v[116:119], v[220:223]
  v_mfma_f32_16x16x32_bf16 v[220:223], v[76:79], v[112:115], v[220:223]
  v_mfma_f32_16x16x32_bf16 v[220:223], v[80:83], v[108:111], v[220:223]
  v_mfma_f32_16x16x32_bf16 v[220:223], v[84:87], v[104:107], v[220:223]
  v_mfma_f32_16x16x32_bf16 v[220:223], v[88:91], v[100:103], v[220:223]
  v_mfma_f32_16x16x32_bf16 v[220:223], v[92:95], v[96:99], v[220:223]
  s_waitcnt lgkmcnt(0)
  v_mfma_f32_16x16x32_bf16 v[192:195], v[128:131], v[160:163], v[192:195]
  ds_read_b64 v[64:65], v35 offset:128
  v_mfma_f32_16x16x32_bf16 v[196:199], v[128:131], v[164:167], v[196:199]
  ds_read_b64 v[66:67], v35 offset:136
  v_mfma_f32_16x16x32_bf16 v[196:199], v[132:135], v[160:163], v[196:199]
  ds_read_b128 v[96:99], v29 offset:3712
  v_mfma_f32_16x16x32_bf16 v[200:203], v[128:131], v[168:171], v[200:203]
  ds_read_b64 v[68:69], v35 offset:640
  v_mfma_f32_16x16x32_bf16 v[200:203], v[132:135], v[164:167], v[200:203]
  ds_read_b64 v[70:71], v35 offset:648
  v_mfma_f32_16x16x32_bf16 v[200:203], v[136:139], v[160:163], v[200:203]
  ds_read_b128 v[100:103], v29 offset:3200
  v_mfma_f32_16x16x32_bf16 v[204:207], v[128:131], v[172:175], v[204:207]
  ds_read_b64 v[72:73], v35 offset:1152
  v_mfma_f32_16x16x32_bf16 v[204:207], v[132:135], v[168:171], v[204:207]
  ds_read_b64 v[74:75], v35 offset:1160
  v_mfma_f32_16x16x32_bf16 v[204:207], v[136:139], v[164:167], v[204:207]
  ds_read_b128 v[104:107], v29 offset:2688
  v_mfma_f32_16x16x32_bf16 v[204:207], v[140:143], v[160:163], v[204:207]
  ds_read_b64 v[76:77], v35 offset:1664
  v_mfma_f32_16x16x32_bf16 v[208:211], v[128:131], v[176:179], v[208:211]
  ds_read_b64 v[78:79], v35 offset:1672
  v_mfma_f32_16x16x32_bf16 v[208:211], v[132:135], v[172:175], v[208:211]
  ds_read_b128 v[108:111], v29 offset:2176
  v_mfma_f32_16x16x32_bf16 v[208:211], v[136:139], v[168:171], v[208:211]
  ds_read_b64 v[80:81], v35 offset:2176
  v_mfma_f32_16x16x32_bf16 v[208:211], v[140:143], v[164:167], v[208:211]
  ds_read_b64 v[82:83], v35 offset:2184
  v_mfma_f32_16x16x32_bf16 v[208:211], v[144:147], v[160:163], v[208:211]
  ds_read_b128 v[112:115], v29 offset:1664
  v_mfma_f32_16x16x32_bf16 v[212:215], v[128:131], v[180:183], v[212:215]
  ds_read_b64 v[84:85], v35 offset:2688
  v_mfma_f32_16x16x32_bf16 v[212:215], v[132:135], v[176:179], v[212:215]
  ds_read_b64 v[86:87], v35 offset:2696
  v_mfma_f32_16x16x32_bf16 v[212:215], v[136:139], v[172:175], v[212:215]
  ds_read_b128 v[116:119], v29 offset:1152
  v_mfma_f32_16x16x32_bf16 v[212:215], v[140:143], v[168:171], v[212:215]
  ds_read_b64 v[88:89], v35 offset:3200
  v_mfma_f32_16x16x32_bf16 v[212:215], v[144:147], v[164:167], v[212:215]
  ds_read_b64 v[90:91], v35 offset:3208
  v_mfma_f32_16x16x32_bf16 v[212:215], v[148:151], v[160:163], v[212:215]
  ds_read_b128 v[120:123], v29 offset:640
  v_mfma_f32_16x16x32_bf16 v[216:219], v[128:131], v[184:187], v[216:219]
  ds_read_b64 v[92:93], v35 offset:3712
  v_mfma_f32_16x16x32_bf16 v[216:219], v[132:135], v[180:183], v[216:219]
  ds_read_b64 v[94:95], v35 offset:3720
  v_mfma_f32_16x16x32_bf16 v[216:219], v[136:139], v[176:179], v[216:219]
  ds_read_b128 v[124:127], v29 offset:128
  v_mfma_f32_16x16x32_bf16 v[216:219], v[140:143], v[172:175], v[216:219]
  v_mfma_f32_16x16x32_bf16 v[216:219], v[144:147], v[168:171], v[216:219]
  v_mfma_f32_16x16x32_bf16 v[216:219], v[148:151], v[164:167], v[216:219]
  v_mfma_f32_16x16x32_bf16 v[216:219], v[152:155], v[160:163], v[216:219]
  v_mfma_f32_16x16x32_bf16 v[220:223], v[128:131], v[188:191], v[220:223]
  v_mfma_f32_16x16x32_bf16 v[220:223], v[132:135], v[184:187], v[220:223]
  v_mfma_f32_16x16x32_bf16 v[220:223], v[136:139], v[180:183], v[220:223]
  v_mfma_f32_16x16x32_bf16 v[220:223], v[140:143], v[176:179], v[220:223]
  v_mfma_f32_16x16x32_bf16 v[220:223], v[144:147], v[172:175], v[220:223]
  v_mfma_f32_16x16x32_bf16 v[220:223], v[148:151], v[168:171], v[220:223]
  v_mfma_f32_16x16x32_bf16 v[220:223], v[152:155], v[164:167], v[220:223]
  v_mfma_f32_16x16x32_bf16 v[220:223], v[156:159], v[160:163], v[220:223]
  s_waitcnt lgkmcnt(0)
  v_mfma_f32_16x16x32_bf16 v[192:195], v[64:67], v[96:99], v[192:195]
  ds_read_b64 v[128:129], v35 offset:192
  v_mfma_f32_16x16x32_bf16 v[196:199], v[64:67], v[100:103], v[196:199]
  ds_read_b64 v[130:131], v35 offset:200
  v_mfma_f32_16x16x32_bf16 v[196:199], v[68:71], v[96:99], v[196:199]
  ds_read_b128 v[160:163], v29 offset:3776
  v_mfma_f32_16x16x32_bf16 v[200:203], v[64:67], v[104:107], v[200:203]
  ds_read_b64 v[132:133], v35 offset:704
  v_mfma_f32_16x16x32_bf16 v[200:203], v[68:71], v[100:103], v[200:203]
  ds_read_b64 v[134:135], v35 offset:712
  v_mfma_f32_16x16x32_bf16 v[200:203], v[72:75], v[96:99], v[200:203]
  ds_read_b128 v[164:167], v29 offset:3264
  v_mfma_f32_16x16x32_bf16 v[204:207], v[64:67], v[108:111], v[204:207]
  ds_read_b64 v[136:137], v35 offset:1216
  v_mfma_f32_16x16x32_bf16 v[204:207], v[68:71], v[104:107], v[204:207]
  ds_read_b64 v[138:139], v35 offset:1224
  v_mfma_f32_16x16x32_bf16 v[204:207], v[72:75], v[100:103], v[204:207]
  ds_read_b128 v[168:171], v29 offset:2752
  v_mfma_f32_16x16x32_bf16 v[204:207], v[76:79], v[96:99], v[204:207]
  ds_read_b64 v[140:141], v35 offset:1728
  v_mfma_f32_16x16x32_bf16 v[208:211], v[64:67], v[112:115], v[208:211]
  ds_read_b64 v[142:143], v35 offset:1736
  v_mfma_f32_16x16x32_bf16 v[208:211], v[68:71], v[108:111], v[208:211]
  ds_read_b128 v[172:175], v29 offset:2240
  v_mfma_f32_16x16x32_bf16 v[208:211], v[72:75], v[104:107], v[208:211]
  ds_read_b64 v[144:145], v35 offset:2240
  v_mfma_f32_16x16x32_bf16 v[208:211], v[76:79], v[100:103], v[208:211]
  ds_read_b64 v[146:147], v35 offset:2248
  v_mfma_f32_16x16x32_bf16 v[208:211], v[80:83], v[96:99], v[208:211]
  ds_read_b128 v[176:179], v29 offset:1728
  v_mfma_f32_16x16x32_bf16 v[212:215], v[64:67], v[116:119], v[212:215]
  ds_read_b64 v[148:149], v35 offset:2752
  v_mfma_f32_16x16x32_bf16 v[212:215], v[68:71], v[112:115], v[212:215]
  ds_read_b64 v[150:151], v35 offset:2760
  v_mfma_f32_16x16x32_bf16 v[212:215], v[72:75], v[108:111], v[212:215]
  ds_read_b128 v[180:183], v29 offset:1216
  v_mfma_f32_16x16x32_bf16 v[212:215], v[76:79], v[104:107], v[212:215]
  ds_read_b64 v[152:153], v35 offset:3264
  v_mfma_f32_16x16x32_bf16 v[212:215], v[80:83], v[100:103], v[212:215]
  ds_read_b64 v[154:155], v35 offset:3272
  v_mfma_f32_16x16x32_bf16 v[212:215], v[84:87], v[96:99], v[212:215]
  ds_read_b128 v[184:187], v29 offset:704
  v_mfma_f32_16x16x32_bf16 v[216:219], v[64:67], v[120:123], v[216:219]
  ds_read_b64 v[156:157], v35 offset:3776
  v_mfma_f32_16x16x32_bf16 v[216:219], v[68:71], v[116:119], v[216:219]
  ds_read_b64 v[158:159], v35 offset:3784
  v_mfma_f32_16x16x32_bf16 v[216:219], v[72:75], v[112:115], v[216:219]
  ds_read_b128 v[188:191], v29 offset:192
  v_mfma_f32_16x16x32_bf16 v[216:219], v[76:79], v[108:111], v[216:219]
  v_mfma_f32_16x16x32_bf16 v[216:219], v[80:83], v[104:107], v[216:219]
  v_mfma_f32_16x16x32_bf16 v[216:219], v[84:87], v[100:103], v[216:219]
  v_mfma_f32_16x16x32_bf16 v[216:219], v[88:91], v[96:99], v[216:219]
  v_mfma_f32_16x16x32_bf16 v[220:223], v[64:67], v[124:127], v[220:223]
  v_mfma_f32_16x16x32_bf16 v[220:223], v[68:71], v[120:123], v[220:223]
  v_mfma_f32_16x16x32_bf16 v[220:223], v[72:75], v[116:119], v[220:223]
  v_mfma_f32_16x16x32_bf16 v[220:223], v[76:79], v[112:115], v[220:223]
  v_mfma_f32_16x16x32_bf16 v[220:223], v[80:83], v[108:111], v[220:223]
  v_mfma_f32_16x16x32_bf16 v[220:223], v[84:87], v[104:107], v[220:223]
  v_mfma_f32_16x16x32_bf16 v[220:223], v[88:91], v[100:103], v[220:223]
  v_mfma_f32_16x16x32_bf16 v[220:223], v[92:95], v[96:99], v[220:223]
  s_waitcnt lgkmcnt(0)
  v_mfma_f32_16x16x32_bf16 v[192:195], v[128:131], v[160:163], v[192:195]
  v_mfma_f32_16x16x32_bf16 v[196:199], v[128:131], v[164:167], v[196:199]
  v_mfma_f32_16x16x32_bf16 v[196:199], v[132:135], v[160:163], v[196:199]
  v_mfma_f32_16x16x32_bf16 v[200:203], v[128:131], v[168:171], v[200:203]
  v_mfma_f32_16x16x32_bf16 v[200:203], v[132:135], v[164:167], v[200:203]
  v_mfma_f32_16x16x32_bf16 v[200:203], v[136:139], v[160:163], v[200:203]
  v_mfma_f32_16x16x32_bf16 v[204:207], v[128:131], v[172:175], v[204:207]
  v_mfma_f32_16x16x32_bf16 v[204:207], v[132:135], v[168:171], v[204:207]
  v_mfma_f32_16x16x32_bf16 v[204:207], v[136:139], v[164:167], v[204:207]
  v_mfma_f32_16x16x32_bf16 v[204:207], v[140:143], v[160:163], v[204:207]
  v_mfma_f32_16x16x32_bf16 v[208:211], v[128:131], v[176:179], v[208:211]
  v_mfma_f32_16x16x32_bf16 v[208:211], v[132:135], v[172:175], v[208:211]
  v_mfma_f32_16x16x32_bf16 v[208:211], v[136:139], v[168:171], v[208:211]
  v_mfma_f32_16x16x32_bf16 v[208:211], v[140:143], v[164:167], v[208:211]
  v_mfma_f32_16x16x32_bf16 v[208:211], v[144:147], v[160:163], v[208:211]
  v_mfma_f32_16x16x32_bf16 v[212:215], v[128:131], v[180:183], v[212:215]
  v_mfma_f32_16x16x32_bf16 v[212:215], v[132:135], v[176:179], v[212:215]
  v_mfma_f32_16x16x32_bf16 v[212:215], v[136:139], v[172:175], v[212:215]
  v_mfma_f32_16x16x32_bf16 v[212:215], v[140:143], v[168:171], v[212:215]
  v_mfma_f32_16x16x32_bf16 v[212:215], v[144:147], v[164:167], v[212:215]
  v_mfma_f32_16x16x32_bf16 v[212:215], v[148:151], v[160:163], v[212:215]
  v_mfma_f32_16x16x32_bf16 v[216:219], v[128:131], v[184:187], v[216:219]
  v_mfma_f32_16x16x32_bf16 v[216:219], v[132:135], v[180:183], v[216:219]
  v_mfma_f32_16x16x32_bf16 v[216:219], v[136:139], v[176:179], v[216:219]
  v_mfma_f32_16x16x32_bf16 v[216:219], v[140:143], v[172:175], v[216:219]
  v_mfma_f32_16x16x32_bf16 v[216:219], v[144:147], v[168:171], v[216:219]
  v_mfma_f32_16x16x32_bf16 v[216:219], v[148:151], v[164:167], v[216:219]
  v_mfma_f32_16x16x32_bf16 v[216:219], v[152:155], v[160:163], v[216:219]
  v_mfma_f32_16x16x32_bf16 v[220:223], v[128:131], v[188:191], v[220:223]
  v_mfma_f32_16x16x32_bf16 v[220:223], v[132:135], v[184:187], v[220:223]
  v_mfma_f32_16x16x32_bf16 v[220:223], v[136:139], v[180:183], v[220:223]
  v_mfma_f32_16x16x32_bf16 v[220:223], v[140:143], v[176:179], v[220:223]
  v_mfma_f32_16x16x32_bf16 v[220:223], v[144:147], v[172:175], v[220:223]
  v_mfma_f32_16x16x32_bf16 v[220:223], v[148:151], v[168:171], v[220:223]
  v_mfma_f32_16x16x32_bf16 v[220:223], v[152:155], v[164:167], v[220:223]
  v_mfma_f32_16x16x32_bf16 v[220:223], v[156:159], v[160:163], v[220:223]
  s_nop 7
  s_mul_i32 s90, s99, 9216
  s_add_u32 s90, s90, 45568
  s_mul_i32 s91, s99, 4608
  s_add_u32 s91, s91, 59392
  s_cmp_eq_u32 s71, 0
  s_cselect_b32 s86, s90, s91
  v_add_u32 v11, s86, v21
  s_cmp_eq_u32 s71, 0
  s_cbranch_scc1 PR_37
  ds_write_b128 v11, v[192:195] offset:0
  ds_write_b128 v11, v[196:199] offset:1024
  ds_write_b128 v11, v[200:203] offset:2048
  ds_write_b128 v11, v[204:207] offset:3072
  s_nop 1
  v_mov_b32 v192, v208
  v_mov_b32 v193, v209
  v_mov_b32 v194, v210
  v_mov_b32 v195, v211
  v_mov_b32 v196, v212
  v_mov_b32 v197, v213
  v_mov_b32 v198, v214
  v_mov_b32 v199, v215
  v_mov_b32 v200, v216
  v_mov_b32 v201, v217
  v_mov_b32 v202, v218
  v_mov_b32 v203, v219
  v_mov_b32 v204, v220
  v_mov_b32 v205, v221
  v_mov_b32 v206, v222
  v_mov_b32 v207, v223
  s_branch PR_38
PR_37:
  ds_write_b128 v11, v[208:211] offset:0
  ds_write_b128 v11, v[212:215] offset:1024
  ds_write_b128 v11, v[216:219] offset:2048
  ds_write_b128 v11, v[220:223] offset:3072
PR_38:
  s_waitcnt lgkmcnt(0)
  ds_write_b32 v30, v31
  s_lshl_b32 s86, s83, 2
  s_add_u32 s86, s86, 158720
  s_xor_b32 s86, s86, 4
  v_mov_b32 v8, s86
  s_mov_b32 s89, 0x200000
LS_39:
  ds_read_b32 v9, v8
  s_waitcnt lgkmcnt(0)
  v_readfirstlane_b32 s88, v9
  s_nop 3
  s_cmp_eq_u32 s88, 1
  s_cbranch_scc1 LSD_40
  s_sub_u32 s89, s89, 1
  s_cmp_eq_u32 s89, 0
  s_cbranch_scc1 LSD_40
  s_sleep 1
  s_branch LS_39
LSD_40:
  s_mul_i32 s90, s99, 9216
  s_add_u32 s90, s90, 45568
  s_mul_i32 s91, s99, 4608
  s_add_u32 s91, s91, 59392
  s_cmp_eq_u32 s71, 1
  s_cselect_b32 s86, s90, s91
  v_add_u32 v11, s86, v21
  ds_read_b128 v[80:83], v11 offset:0
  ds_read_b128 v[84:87], v11 offset:1024
  ds_read_b128 v[88:91], v11 offset:2048
  ds_read_b128 v[92:95], v11 offset:3072
  s_waitcnt lgkmcnt(0)
  ds_write_b32 v30, v31 offset:112
  v_add_f32 v192, v192, v80
  v_add_f32 v193, v193, v81
  v_add_f32 v194, v194, v82
  v_add_f32 v195, v195, v83
  v_add_f32 v196, v196, v84
  v_add_f32 v197, v197, v85
  v_add_f32 v198, v198, v86
  v_add_f32 v199, v199, v87
  v_add_f32 v200, v200, v88
  v_add_f32 v201, v201, v89
  v_add_f32 v202, v202, v90
  v_add_f32 v203, v203, v91
  v_add_f32 v204, v204, v92
  v_add_f32 v205, v205, v93
  v_add_f32 v206, v206, v94
  v_add_f32 v207, v207, v95
  v_and_b32 v112, 0xffff0000, v225
  v_lshlrev_b32 v113, 16, v225
  v_and_b32 v114, 0xffff0000, v224
  v_lshlrev_b32 v115, 16, v224
  v_fma_f32 v192, v112, v32, v192
  v_fma_f32 v193, v113, v32, v193
  v_fma_f32 v194, v114, v32, v194
  v_fma_f32 v195, v115, v32, v195
  v_cvt_pk_bf16_f32 v96, v192, v193
  v_cvt_pk_bf16_f32 v97, v194, v195
  v_and_b32 v116, 0xffff0000, v227
  v_lshlrev_b32 v117, 16, v227
  v_and_b32 v118, 0xffff0000, v226
  v_lshlrev_b32 v119, 16, v226
  v_fma_f32 v196, v116, v32, v196
  v_fma_f32 v197, v117, v32, v197
  v_fma_f32 v198, v118, v32, v198
  v_fma_f32 v199, v119, v32, v199
  v_cvt_pk_bf16_f32 v98, v196, v197
  v_cvt_pk_bf16_f32 v99, v198, v199
  v_and_b32 v112, 0xffff0000, v229
  v_lshlrev_b32 v113, 16, v229
  v_and_b32 v114, 0xffff0000, v228
  v_lshlrev_b32 v115, 16, v228
  v_fma_f32 v200, v112, v32, v200
  v_fma_f32 v201, v113, v32, v201
  v_fma_f32 v202, v114, v32, v202
  v_fma_f32 v203, v115, v32, v203
  v_cvt_pk_bf16_f32 v100, v200, v201
  v_cvt_pk_bf16_f32 v101, v202, v203
  v_and_b32 v116, 0xffff0000, v231
  v_lshlrev_b32 v117, 16, v231
  v_and_b32 v118, 0xffff0000, v230
  v_lshlrev_b32 v119, 16, v230
  v_fma_f32 v204, v116, v32, v204
  v_fma_f32 v205, v117, v32, v205
  v_fma_f32 v206, v118, v32, v206
  v_fma_f32 v207, v119, v32, v207
  v_cvt_pk_bf16_f32 v102, v204, v205
  v_cvt_pk_bf16_f32 v103, v206, v207
  s_nop 1
  v_permlane16_swap_b32 v96, v98
  v_permlane16_swap_b32 v97, v99
  v_permlane16_swap_b32 v100, v102
  v_permlane16_swap_b32 v101, v103
  v_and_b32 v8, 15, v3
  v_lshrrev_b32 v9, 4, v3
  v_and_b32 v10, 1, v9
  v_lshlrev_b32 v10, 9, v10
  v_and_b32 v9, 2, v9
  v_lshlrev_b32 v9, 3, v9
  v_lshlrev_b32 v8, 5, v8
  v_add3_u32 v8, v8, v9, v10
  s_lshl_b32 s86, s62, 12
  s_lshl_b32 s87, s71, 11
  s_add_u32 s86, s86, s87
  s_add_u32 s86, s86, 2097152
  buffer_store_dwordx4 v[96:99], v8, s[24:27], s86 offen offset:0 sc0 sc1
  buffer_store_dwordx4 v[100:103], v8, s[24:27], s86 offen offset:1024 sc0 sc1
  s_waitcnt vmcnt(0)
  s_lshr_b32 s86, s62, 6
  s_lshl_b32 s86, s86, 9
  s_and_b32 s87, s2, 31
  s_lshl_b32 s87, s87, 4
  s_lshl_b32 s88, s83, 2
  s_add_u32 s86, s86, s87
  s_add_u32 s86, s86, s88
  s_add_u32 s86, s86, 13643776
  v_mov_b32 v8, s85
  s_mov_b64 s[100:101], exec
  s_mov_b64 exec, 1
  buffer_store_dword v8, off, s[24:27], s86 sc0 sc1
  s_mov_b64 exec, s[100:101]
  s_cmp_lg_u32 s83, 0
  s_cbranch_scc1 YP_41
  s_mov_b32 s86, 158784
  v_mov_b32 v8, s86
  s_mov_b32 s89, 0x200000
LS_43:
  ds_read_b32 v9, v8
  s_waitcnt lgkmcnt(0)
  v_readfirstlane_b32 s88, v9
  s_nop 3
  s_cmp_eq_u32 s88, 1
  s_cbranch_scc1 LSD_44
  s_sub_u32 s89, s89, 1
  s_cmp_eq_u32 s89, 0
  s_cbranch_scc1 LSD_44
  s_sleep 4
  s_branch LS_43
LSD_44:
  s_lshl_b32 s86, s80, 9
  s_add_u32 s86, s86, 13643776
  s_mov_b32 s89, 0x40000
POLL_45:
  v_lshlrev_b32 v13, 3, v3
  buffer_load_dwordx2 v[114:115], v13, s[24:27], s86 offen sc1
  s_waitcnt vmcnt(0)
  v_cmp_eq_u32 vcc, s85, v114
  v_cmp_eq_u32 s[90:91], s85, v115
  s_nop 1
  s_and_b64 vcc, vcc, s[90:91]
  s_cmp_eq_u64 vcc, -1
  s_cbranch_scc1 POLLD_46
  s_sub_u32 s89, s89, 1
  s_cmp_eq_u32 s89, 0
  s_cbranch_scc1 POLLD_46
  s_sleep 12
  s_branch POLL_45
POLLD_46:
  v_mov_b32 v8, 158788
  v_mov_b32 v9, 1
  ds_write_b32 v8, v9
  s_branch YP_42
YP_41:
  s_mov_b32 s86, 158788
  v_mov_b32 v8, s86
  s_mov_b32 s89, 0x200000
LS_47:
  ds_read_b32 v9, v8
  s_waitcnt lgkmcnt(0)
  v_readfirstlane_b32 s88, v9
  s_nop 3
  s_cmp_eq_u32 s88, 1
  s_cbranch_scc1 LSD_48
  s_sub_u32 s89, s89, 1
  s_cmp_eq_u32 s89, 0
  s_cbranch_scc1 LSD_48
  s_sleep 4
  s_branch LS_47
LSD_48:
YP_42:
  v_lshrrev_b32 v8, 3, v3
  v_and_b32 v9, 7, v3
  s_lshl_b32 s86, s83, 4
  v_add_u32 v8, s86, v8
  v_lshlrev_b32 v10, 12, v8
  v_lshl_add_u32 v10, v9, 4, v10
  s_lshl_b32 s86, s80, 18
  s_lshl_b32 s87, s79, 7
  s_add_u32 s86, s86, s87
  s_add_u32 s86, s86, 2097152
  buffer_load_dwordx4 v[64:67], v10, s[24:27], s86 offen sc1
  v_add_u32 v10, 32768, v10
  buffer_load_dwordx4 v[68:71], v10, s[24:27], s86 offen sc1
  v_mul_u32_u24 v11, 144, v8
  v_lshl_add_u32 v11, v9, 4, v11
  v_add_u32 v11, 59392, v11
  v_mov_b32 v12, 158832
  s_mov_b32 s89, 0x200000
XW_49:
  ds_read_b128 v[72:75], v12
  s_waitcnt lgkmcnt(0)
  v_and_b32 v72, v72, v73
  v_and_b32 v74, v74, v75
  v_and_b32 v72, v72, v74
  s_nop 0
  v_readfirstlane_b32 s88, v72
  s_nop 3
  s_cmp_eq_u32 s88, 1
  s_cbranch_scc1 XWD_50
  s_sub_u32 s89, s89, 1
  s_cmp_eq_u32 s89, 0
  s_cbranch_scc0 XW_49
XWD_50:
  s_waitcnt vmcnt(1)
  ds_write_b128 v11, v[64:67]
  s_waitcnt vmcnt(0)
  ds_write_b128 v11, v[68:71] offset:1152
  s_mov_b32 s32, s68
  s_mov_b32 s33, s69
  s_mov_b32 s34, 2097152
  s_mov_b32 s35, 0x20000
L_FINAL:
  s_setprio 0
  v_lshrrev_b32 v8, 5, v3
  v_and_b32 v9, 3, v3
  v_lshl_add_u32 v28, v8, 2, v9
  s_lshl_b32 s86, s76, 3
  v_add_u32 v28, s86, v28
  v_bfe_u32 v29, v3, 2, 3
  s_lshl_b32 s86, s79, 16
  s_lshl_b32 s87, s80, 7
  s_add_u32 s86, s86, s87
  v_lshlrev_b32 v30, 10, v28
  v_lshl_add_u32 v30, v29, 4, v30
  v_add_u32 v30, s86, v30
  buffer_load_dwordx4 v[32:35], v30, s[4:7], 0 offen
  s_lshl_b32 s97, s79, 9
  s_add_u32 s97, s97, 12582912
  v_lshlrev_b32 v31, 3, v28
  buffer_load_dwordx2 v[36:37], v31, s[24:27], s97 offen sc1
  s_waitcnt lgkmcnt(0)
  s_barrier
  v_and_b32 v8, 31, v28
  v_mul_u32_u24 v8, 272, v8
  v_lshl_add_u32 v8, v29, 5, v8
  s_cmp_lt_u32 s76, 4
  s_cselect_b32 s86, 81920, 0
  v_add_u32 v8, s86, v8
  ds_read_b128 v[40:43], v8 offset:0
  ds_read_b128 v[44:47], v8 offset:16
  ds_read_b128 v[48:51], v8 offset:10240
  ds_read_b128 v[52:55], v8 offset:10256
  ds_read_b128 v[56:59], v8 offset:20480
  ds_read_b128 v[60:63], v8 offset:20496
  ds_read_b128 v[64:67], v8 offset:30720
  ds_read_b128 v[68:71], v8 offset:30736
  v_bfe_u32 v10, v3, 2, 2
  v_and_b32 v11, 3, v3
  v_bfe_u32 v12, v3, 4, 1
  v_lshl_add_u32 v11, v12, 2, v11
  v_lshl_add_u32 v10, v11, 3, v10
  v_mul_u32_u24 v10, 144, v10
  v_lshrrev_b32 v11, 5, v3
  v_lshlrev_b32 v11, 3, v11
  s_lshl_b32 s86, s76, 4
  s_add_u32 s86, s86, 59392
  v_add3_u32 v10, v10, v11, s86
  ds_read_b64_tr_b16 v[72:73], v10
  ds_read_b64_tr_b16 v[74:75], v10 offset:576
  s_waitcnt lgkmcnt(2)
  v_add_f32 v40, v40, v48
  v_add_f32 v41, v41, v49
  v_add_f32 v42, v42, v50
  v_add_f32 v43, v43, v51
  v_add_f32 v44, v44, v52
  v_add_f32 v45, v45, v53
  v_add_f32 v46, v46, v54
  v_add_f32 v47, v47, v55
  v_add_f32 v40, v40, v56
  v_add_f32 v41, v41, v57
  v_add_f32 v42, v42, v58
  v_add_f32 v43, v43, v59
  v_add_f32 v44, v44, v60
  v_add_f32 v45, v45, v61
  v_add_f32 v46, v46, v62
  v_add_f32 v47, v47, v63
  v_add_f32 v40, v40, v64
  v_add_f32 v41, v41, v65
  v_add_f32 v42, v42, v66
  v_add_f32 v43, v43, v67
  v_add_f32 v44, v44, v68
  v_add_f32 v45, v45, v69
  v_add_f32 v46, v46, v70
  v_add_f32 v47, v47, v71
  v_cvt_pk_bf16_f32 v48, v40, v41
  v_cvt_pk_bf16_f32 v50, v42, v43
  v_cvt_pk_bf16_f32 v52, v44, v45
  v_cvt_pk_bf16_f32 v54, v46, v47
  v_and_b32 v41, 0xffff0000, v48
  v_lshlrev_b32 v40, 16, v48
  v_and_b32 v43, 0xffff0000, v50
  v_lshlrev_b32 v42, 16, v50
  v_and_b32 v45, 0xffff0000, v52
  v_lshlrev_b32 v44, 16, v52
  v_and_b32 v47, 0xffff0000, v54
  v_lshlrev_b32 v46, 16, v54
  s_mov_b32 s86, 0xbfb8aa3b
  v_mul_f32 v48, s86, v40
  v_mul_f32 v49, s86, v41
  v_mul_f32 v50, s86, v42
  v_mul_f32 v51, s86, v43
  v_mul_f32 v52, s86, v44
  v_mul_f32 v53, s86, v45
  v_mul_f32 v54, s86, v46
  v_mul_f32 v55, s86, v47
  v_exp_f32 v48, v48
  v_exp_f32 v49, v49
  v_exp_f32 v50, v50
  v_exp_f32 v51, v51
  v_exp_f32 v52, v52
  v_exp_f32 v53, v53
  v_exp_f32 v54, v54
  v_exp_f32 v55, v55
  v_add_f32 v48, 1.0, v48
  v_add_f32 v49, 1.0, v49
  v_add_f32 v50, 1.0, v50
  v_add_f32 v51, 1.0, v51
  v_add_f32 v52, 1.0, v52
  v_add_f32 v53, 1.0, v53
  v_add_f32 v54, 1.0, v54
  v_add_f32 v55, 1.0, v55
  v_rcp_f32 v48, v48
  v_rcp_f32 v49, v49
  v_rcp_f32 v50, v50
  v_rcp_f32 v51, v51
  v_rcp_f32 v52, v52
  v_rcp_f32 v53, v53
  v_rcp_f32 v54, v54
  v_rcp_f32 v55, v55
  s_nop 0
  v_mul_f32 v40, v40, v48
  v_mul_f32 v41, v41, v49
  v_mul_f32 v42, v42, v50
  v_mul_f32 v43, v43, v51
  v_mul_f32 v44, v44, v52
  v_mul_f32 v45, v45, v53
  v_mul_f32 v46, v46, v54
  v_mul_f32 v47, v47, v55
  s_waitcnt vmcnt(0) lgkmcnt(0)
  s_mov_b32 s89, 0x40000
FS_51:
  v_cmp_eq_u32 vcc, s85, v37
  s_nop 1
  s_cmp_eq_u64 vcc, -1
  s_cbranch_scc1 FS_52
  s_sub_u32 s89, s89, 1
  s_cmp_eq_u32 s89, 0
  s_cbranch_scc1 FS_52
  buffer_load_dwordx2 v[36:37], v31, s[24:27], s97 offen sc1
  s_waitcnt vmcnt(0)
  s_branch FS_51
FS_52:
  v_lshlrev_b32 v56, 16, v32
  v_and_b32 v57, 0xffff0000, v32
  v_lshlrev_b32 v64, 16, v72
  v_and_b32 v65, 0xffff0000, v72
  v_lshlrev_b32 v58, 16, v33
  v_and_b32 v59, 0xffff0000, v33
  v_lshlrev_b32 v66, 16, v73
  v_and_b32 v67, 0xffff0000, v73
  v_lshlrev_b32 v60, 16, v34
  v_and_b32 v61, 0xffff0000, v34
  v_lshlrev_b32 v68, 16, v74
  v_and_b32 v69, 0xffff0000, v74
  v_lshlrev_b32 v62, 16, v35
  v_and_b32 v63, 0xffff0000, v35
  v_lshlrev_b32 v70, 16, v75
  v_and_b32 v71, 0xffff0000, v75
  v_and_b32 v37, 0xffff0000, v36
  v_lshlrev_b32 v36, 16, v36
  v_rcp_f32 v37, v37
  v_sub_f32 v48, v56, v36
  v_sub_f32 v49, v57, v36
  v_sub_f32 v50, v58, v36
  v_sub_f32 v51, v59, v36
  v_sub_f32 v52, v60, v36
  v_sub_f32 v53, v61, v36
  v_sub_f32 v54, v62, v36
  v_sub_f32 v55, v63, v36
  v_mul_f32 v48, v48, v37
  v_mul_f32 v49, v49, v37
  v_mul_f32 v50, v50, v37
  v_mul_f32 v51, v51, v37
  v_mul_f32 v52, v52, v37
  v_mul_f32 v53, v53, v37
  v_mul_f32 v54, v54, v37
  v_mul_f32 v55, v55, v37
  v_cvt_pk_bf16_f32 v48, v48, v49
  v_cvt_pk_bf16_f32 v50, v50, v51
  v_cvt_pk_bf16_f32 v52, v52, v53
  v_cvt_pk_bf16_f32 v54, v54, v55
  v_and_b32 v49, 0xffff0000, v48
  v_lshlrev_b32 v48, 16, v48
  v_and_b32 v51, 0xffff0000, v50
  v_lshlrev_b32 v50, 16, v50
  v_and_b32 v53, 0xffff0000, v52
  v_lshlrev_b32 v52, 16, v52
  v_and_b32 v55, 0xffff0000, v54
  v_lshlrev_b32 v54, 16, v54
  v_mul_f32 v48, v48, v64
  v_mul_f32 v49, v49, v65
  v_mul_f32 v50, v50, v66
  v_mul_f32 v51, v51, v67
  v_mul_f32 v52, v52, v68
  v_mul_f32 v53, v53, v69
  v_mul_f32 v54, v54, v70
  v_mul_f32 v55, v55, v71
  v_mul_f32 v48, v48, v40
  v_mul_f32 v49, v49, v41
  v_mul_f32 v50, v50, v42
  v_mul_f32 v51, v51, v43
  v_mul_f32 v52, v52, v44
  v_mul_f32 v53, v53, v45
  v_mul_f32 v54, v54, v46
  v_mul_f32 v55, v55, v47
  v_add_f32 v48, v48, v56
  v_add_f32 v49, v49, v57
  v_add_f32 v50, v50, v58
  v_add_f32 v51, v51, v59
  v_add_f32 v52, v52, v60
  v_add_f32 v53, v53, v61
  v_add_f32 v54, v54, v62
  v_add_f32 v55, v55, v63
  v_cvt_pk_bf16_f32 v72, v48, v49
  v_cvt_pk_bf16_f32 v73, v50, v51
  v_cvt_pk_bf16_f32 v74, v52, v53
  v_cvt_pk_bf16_f32 v75, v54, v55
  buffer_store_dwordx4 v[72:75], v30, s[32:35], 0 offen
L_END:
  s_endpgm
L_CODE_END:
.section .rodata,"a"
.p2align 6
.amdhsa_kernel recurrent_scan__ssm_conv_h3__glu_gated_geglu__prompt_kernel
  .amdhsa_next_free_vgpr 256
  .amdhsa_next_free_sgpr 102
  .amdhsa_accum_offset 256
  .amdhsa_group_segment_fixed_size 0
  .amdhsa_kernarg_size 104
  .amdhsa_user_sgpr_count 2
  .amdhsa_user_sgpr_kernarg_segment_ptr 1
  .amdhsa_system_sgpr_workgroup_id_x 1
.end_amdhsa_kernel
```
